```python
import torch

def _softmax(x, axis=-1):
    return torch.softmax(x, dim=axis)
def _gelu(x):
    return torch.nn.functional.gelu(x, approximate="tanh")
def _silu(x):
    return torch.nn.functional.silu(x)
def _sigmoid(x):
    return torch.sigmoid(x)
def _layernorm(x, axis=-1, eps=1e-5):
    m = x.mean(dim=axis, keepdim=True)
    v = x.var(dim=axis, keepdim=True, unbiased=False)
    return (x - m) / torch.sqrt(v + eps)
def _scatter_add(tgt, idx, src, axis=0):
    return tgt.clone().index_add_(axis, idx, src)
def _segment_sum(src, seg, n):
    out = torch.zeros((n,) + src.shape[1:], dtype=src.dtype)
    return out.index_add_(0, seg, src)
def _pad(x, pw):
    flat = tuple(v for pair in reversed(pw) for v in pair)
    return torch.nn.functional.pad(x, flat)

kernel_name = 'gated_mix__spectral_fnet__linear_kernel_hedgehog__prompt'

def setup_inputs():

    _w = (lambda a: (lambda t: t.to(torch.bfloat16) if t.is_floating_point() else t)(torch.as_tensor(a)))
    def _A_setup():
        B, S, D = 1, 2048, 448
        ns = torch.arange(S)[:, None] * torch.arange(S)[None, :]
        nd = torch.arange(D)[:, None] * torch.arange(D)[None, :]
        Ws_re = torch.cos(-2.0 * torch.pi * ns / S).to(float)
        Ws_im = torch.sin(-2.0 * torch.pi * ns / S).to(float)
        Wd_re = torch.cos(-2.0 * torch.pi * nd / D).to(float)
        Wd_im = torch.sin(-2.0 * torch.pi * nd / D).to(float)
        return {
            "x": _w((lambda *s: torch.randn(*s, dtype=torch.bfloat16) * 0.1)(B, S, D)),
            "dft_seq_re": _w(Ws_re),
            "dft_seq_im": _w(Ws_im),
            "dft_hid_re": _w(Wd_re),
            "dft_hid_im": _w(Wd_im),
        }
    _A_in = _A_setup()

    def _B_setup():
        B, S, D, H = 1, 2048, 448, 16
        Dh = D // H
        return {
            "x": _w((lambda *s: torch.randn(*s, dtype=torch.bfloat16) * 0.1)(B, S, D)),
            "wqkv": _w((lambda *s: torch.randn(*s, dtype=torch.bfloat16) * 1.6)(D, 3 * D)),
            "w_phi": _w((lambda *s: torch.randn(*s, dtype=torch.bfloat16) * 1.6)(H, Dh, Dh) * (Dh ** -0.5)),
            "wo": _w((lambda *s: torch.randn(*s, dtype=torch.bfloat16) * 1.6)(D, D)),
        }
    _B_in = _B_setup()

    return {
        "A_x": _A_in["x"],
        "A_dft_seq_re": _A_in["dft_seq_re"],
        "A_dft_seq_im": _A_in["dft_seq_im"],
        "A_dft_hid_re": _A_in["dft_hid_re"],
        "A_dft_hid_im": _A_in["dft_hid_im"],
        "B_x": _B_in["x"],
        "B_wqkv": _B_in["wqkv"],
        "B_w_phi": _B_in["w_phi"],
        "B_wo": _B_in["wo"],
        "gate_w": _w((lambda *s: torch.randn(*s, dtype=torch.bfloat16) * 0.1)(448) * 16.0),
    }

def reference(A_x, A_dft_seq_re, A_dft_seq_im, A_dft_hid_re, A_dft_hid_im, B_x, B_wqkv, B_w_phi, B_wo, gate_w):
    def _A_ref(x, dft_seq_re, dft_seq_im, dft_hid_re, dft_hid_im):
        a = torch.einsum("bsd,ed->bse", x, dft_hid_re)
        b = torch.einsum("bsd,ed->bse", x, dft_hid_im)
        y = torch.einsum("ts,bse->bte", dft_seq_re, a) - torch.einsum("ts,bse->bte", dft_seq_im, b)
        return y

    def _B_ref(x, wqkv, w_phi, wo):
        B, S, D = x.shape
        H = 16; Dh = D // H
        qkv = (lambda x, *d: x.permute(*d))((x @ wqkv).reshape(B, S, 3, H, Dh), 2, 0, 3, 1, 4)
        q, k, v = qkv[0], qkv[1], qkv[2]
        pq = torch.einsum("bhsd,hdf->bhsf", q, w_phi)
        pk = torch.einsum("bhsd,hdf->bhsf", k, w_phi)
        phi_q = torch.concatenate([_softmax(pq, axis=-1), _softmax(-pq, axis=-1)], axis=-1)
        phi_k = torch.concatenate([_softmax(pk, axis=-1), _softmax(-pk, axis=-1)], axis=-1)
        kv = torch.einsum("bhsf,bhsd->bhfd", phi_k, v)
        z  = torch.einsum("bhsf->bhf", phi_k)
        num = torch.einsum("bhqf,bhfd->bhqd", phi_q, kv)
        den = torch.einsum("bhqf,bhf->bhq", phi_q, z)[..., None] + 1e-6
        o = num / den
        return (lambda x, *d: x.permute(*d))(o, 0, 2, 1, 3).reshape(B, S, D) @ wo

    x = A_x
    g = _sigmoid((x * gate_w).sum(-1, keepdims=True))
    a = _A_ref(x, A_dft_seq_re, A_dft_seq_im, A_dft_hid_re, A_dft_hid_im)
    b = _B_ref(x, B_wqkv, B_w_phi, B_wo)
    return g * a + (1 - g) * b
```

```asm
; @launch grid=(256,1,1) block=(256,1,1) lds=163840
.amdgcn_target "amdgcn-amd-amdhsa--gfx950"
.text
.globl gated_mix__spectral_fnet__linear_kernel_hedgehog__prompt_kernel
.p2align 8
.type gated_mix__spectral_fnet__linear_kernel_hedgehog__prompt_kernel,@function
gated_mix__spectral_fnet__linear_kernel_hedgehog__prompt_kernel:
    s_cmp_ge_u32 s2, 0x100
    s_cbranch_scc1 .Lend
    s_load_dwordx2 s[4:5], s[0:1], 0
    s_load_dwordx2 s[8:9], s[0:1], 48
    s_load_dwordx2 s[28:29], s[0:1], 96
    s_load_dwordx2 s[20:21], s[0:1], 72
    s_load_dwordx2 s[12:13], s[0:1], 56
    s_load_dwordx2 s[16:17], s[0:1], 64
    s_load_dwordx2 s[24:25], s[0:1], 80
    v_lshrrev_b32 v227, 6, v0
    v_and_b32 v0, 63, v0
    v_readfirstlane_b32 s32, v227
    s_lshr_b32 s64, s2, 3
    s_and_b32 s33, s2, 3
    s_and_b32 s39, s64, 3
    s_lshl2_add_u32 s33, s39, s33
    s_lshr_b32 s47, s2, 5
    s_add_u32 s36, s39, s47
    s_lshl_b32 s36, s36, 2
    s_mov_b32 s68, 0x64206420
    s_mov_b32 s69, 0x64206420
    s_lshr_b64 s[68:69], s[68:69], s36
    s_and_b32 s36, s68, 7
    s_lshl2_add_u32 s58, s33, s32
    s_lshl_b32 s56, s32, 12
    v_lshrrev_b32 v227, 3, v0
    v_lshrrev_b32 v226, 4, v0
    v_xor_b32 v225, v226, v0
    v_and_b32 v225, 7, v225
    v_mul_u32_u24 v227, 0xe000, v227
    s_mul_i32 s38, s58, 896
    v_lshl_add_u32 v227, v225, 4, v227
    v_add_u32 v252, s38, v227
    s_mov_b32 s39, 0x6fc00
    v_xad_u32 v253, v252, 64, s39
    v_add_u32 v254, 0xdf800, v252
    v_add_u32 v255, 0xdf800, v253
    s_lshl_b32 s40, s36, 7
    s_mov_b32 s6, 0x1c0000
    s_mov_b32 s7, 0x20000
    s_mov_b32 s10, 0x126000
    s_mov_b32 s11, 0x20000
    s_mov_b32 s14, 0x6200
    s_mov_b32 s15, 0x20000
    s_mov_b32 s22, 0x380
    s_mov_b32 s23, 0x20000
    s_mov_b32 s30, 0x1000000
    s_mov_b32 s31, 0x20000
    s_lshl_b32 s47, s47, 2
    s_lshr_b32 s68, 0x67543210, s47
    s_lshr_b32 s69, 0xdefcba98, s47
    s_and_b32 s68, s68, 15
    s_and_b32 s69, s69, 15
    s_bitcmp1_b32 s2, 2
    s_cselect_b32 s34, s69, s68
    s_cselect_b32 s35, 16, 0
    s_cselect_b32 s47, 0, 1792
    s_lshl_b32 s57, s32, 10
    s_mul_i32 s48, s40, 1344
    v_lshrrev_b32 v227, 2, v0
    v_and_b32 v224, 3, v0
    v_lshlrev_b32 v224, 4, v224
    v_min_u32 v224, 40, v224
    s_movk_i32 s39, 2688
    v_mad_u32_u24 v245, v227, s39, v224
    s_mul_i32 s38, s32, 43008
    s_mul_i32 s39, s34, 56
    s_add_u32 s39, s39, s38
    s_add_u32 s39, s39, 896
    v_add_u32 v219, s39, v245
    s_cmp_ge_u32 s58, 56
    s_cselect_b32 s38, 8, 0
    s_sub_u32 s38, s58, s38
    s_cmp_ge_u32 s38, 28
    s_cselect_b32 s39, 28, 0
    s_cselect_b32 s68, s69, s68
    s_sub_u32 s38, s38, s39
    s_add_u32 s35, s35, s68
    s_mul_i32 s39, s68, 56
    s_add_u32 s47, s47, s39
    s_mul_i32 s39, s38, 43008
    s_add_u32 s47, s47, s39
    s_lshl2_add_u32 s35, s35, s32
    s_lshr_b32 s38, s38, 2
    s_lshl3_add_u32 s39, s35, s38
    s_lshl_b32 s39, s39, 5
    s_add_u32 s55, s39, 0x60000
    s_mul_i32 s35, s35, 7
    s_add_u32 s35, s35, s38
    s_lshl_b32 s35, s35, 10
    s_add_u32 s35, s35, 0x600000
    s_add_u32 s41, s40, 128
    s_cmp_eq_u32 s41, 896
    s_cselect_b32 s41, 0, s41
    s_mul_i32 s49, s41, 1344
    v_lshlrev_b32 v218, 4, v0
    s_mul_i32 s38, s34, 1568
    s_add_u32 s38, s38, s57
    s_cmp_ge_u32 s32, 2
    s_cselect_b32 s65, 0x40000000, s38
    v_lshrrev_b32 v222, 1, v0
    v_add_u32 v221, s36, v222
    v_subrev_u32 v220, 7, v221
    v_min_u32 v221, v221, v220
    v_and_b32 v220, 1, v0
    v_lshlrev_b32 v227, 4, v220
    v_lshl_add_u32 v221, v221, 7, v227
    v_lshl_add_u32 v244, s32, 5, v221
    v_lshrrev_b32 v217, 5, v0
    v_and_b32 v216, 31, v0
    v_and_b32 v215, 15, v0
    v_lshrrev_b32 v214, 4, v0
    v_lshlrev_b32 v220, 9, v220
    v_lshl_add_u32 v220, v222, 12, v220
    s_add_u32 s38, s57, 0x1f1f0
    v_add_u32 v213, s38, v220
    v_add_u32 v212, 0x1f000, v218
    v_add_u32 v243, s57, v212
    s_mul_i32 s38, s34, 14
    v_add_u32 v227, s38, v215
    v_cvt_f32_u32 v227, v227
    v_mul_f32 v242, 0x3b124925, v227
    v_and_b32 v227, 16, v0
    v_cvt_f32_u32 v227, v227
    v_mul_f32 v227, 0x3c800000, v227
    s_lshr_b32 s38, s40, 1
    s_lshl4_add_u32 s38, s32, s38
    v_lshl_add_u32 v226, v217, 3, s38
    v_cvt_f32_u32 v226, v226
    v_fma_f32 v4, v226, v242, v227
    v_mul_f32 v246, 0x42800000, v242
    v_fract_f32 v4, v4
    v_fract_f32 v246, v246
    v_add_f32 v12, v4, v246
    v_cos_f32 v246, v246
    v_add_f32 v5, v4, v242
    s_add_u32 m0, s57, 0x27000
    s_waitcnt lgkmcnt(0)
    buffer_load_dwordx4 v245, s[8:11], s47 offen sc1 lds
    s_add_u32 m0, s56, 0x0
    s_nop 0
    buffer_load_dwordx4 v252, s[4:7], s40 offen offset:0 lds
    buffer_load_dwordx4 v253, s[4:7], s40 offen offset:1024 lds
    buffer_load_dwordx4 v254, s[4:7], s40 offen offset:2048 lds
    buffer_load_dwordx4 v255, s[4:7], s40 offen offset:3072 lds
    s_add_u32 m0, s57, 0x18000
    s_nop 0
    buffer_load_dwordx4 v219, s[8:11], s48 offen sc1 lds
    s_load_dword s37, s[28:29], 0
    s_add_u32 m0, s57, 0x26000
    s_nop 0
    buffer_load_dwordx4 v218, s[12:15], s65 offen lds
    buffer_load_dwordx4 v[248:251], v244, s[20:23], 0 offen
    s_getpc_b64 s[68:69]
    s_lshl2_add_u32 s47, s64, s32
    s_mul_i32 s47, s47, 160
    s_min_u32 s47, s47, 0x4140
    v_lshl_add_u32 v211, v0, 2, s47
    global_load_dword v211, v211, s[68:69]
    v_add_f32 v13, v12, v242
    v_add_f32 v6, v5, v242
    v_add_f32 v14, v13, v242
    v_add_f32 v7, v6, v242
    v_add_f32 v15, v14, v242
    v_add_f32 v8, v7, v242
    v_add_f32 v16, v15, v242
    v_add_f32 v9, v8, v242
    v_add_f32 v17, v16, v242
    v_add_f32 v10, v9, v242
    v_add_f32 v18, v17, v242
    v_add_f32 v11, v10, v242
    v_add_f32 v19, v18, v242
    v_cos_f32 v4, v4
    v_cos_f32 v5, v5
    v_cos_f32 v6, v6
    v_cos_f32 v7, v7
    v_cos_f32 v8, v8
    v_cos_f32 v9, v9
    v_cos_f32 v10, v10
    v_cos_f32 v11, v11
    v_add_f32 v246, v246, v246
    v_cos_f32 v12, v12
    v_cos_f32 v13, v13
    v_cos_f32 v14, v14
    v_cos_f32 v15, v15
    v_cos_f32 v16, v16
    v_cos_f32 v17, v17
    v_cos_f32 v18, v18
    v_cos_f32 v19, v19
    v_cvt_pk_bf16_f32 v20, v4, v5
    v_cvt_pk_bf16_f32 v21, v6, v7
    v_cvt_pk_bf16_f32 v22, v8, v9
    v_cvt_pk_bf16_f32 v23, v10, v11
    ds_write_b128 v243, v[20:23] offset:0
    v_cvt_pk_bf16_f32 v24, v12, v13
    v_cvt_pk_bf16_f32 v25, v14, v15
    v_cvt_pk_bf16_f32 v26, v16, v17
    v_cvt_pk_bf16_f32 v27, v18, v19
    ds_write_b128 v243, v[24:27] offset:4096
    v_fma_f32 v4, v246, v12, -v4
    v_fma_f32 v5, v246, v13, -v5
    v_fma_f32 v6, v246, v14, -v6
    v_fma_f32 v7, v246, v15, -v7
    v_fma_f32 v8, v246, v16, -v8
    v_fma_f32 v9, v246, v17, -v9
    v_fma_f32 v10, v246, v18, -v10
    v_fma_f32 v11, v246, v19, -v11
    v_cvt_pk_bf16_f32 v20, v4, v5
    v_cvt_pk_bf16_f32 v21, v6, v7
    v_cvt_pk_bf16_f32 v22, v8, v9
    v_cvt_pk_bf16_f32 v23, v10, v11
    ds_write_b128 v243, v[20:23] offset:8192
    s_add_u32 s42, s41, 128
    s_cmp_eq_u32 s42, 896
    s_cselect_b32 s42, 0, s42
    s_mul_i32 s50, s42, 1344
    v_fma_f32 v12, v246, v4, -v12
    v_fma_f32 v13, v246, v5, -v13
    v_fma_f32 v14, v246, v6, -v14
    v_fma_f32 v15, v246, v7, -v15
    v_fma_f32 v16, v246, v8, -v16
    v_fma_f32 v17, v246, v9, -v17
    v_fma_f32 v18, v246, v10, -v18
    v_fma_f32 v19, v246, v11, -v19
    v_cvt_pk_bf16_f32 v24, v12, v13
    v_cvt_pk_bf16_f32 v25, v14, v15
    v_cvt_pk_bf16_f32 v26, v16, v17
    v_cvt_pk_bf16_f32 v27, v18, v19
    ds_write_b128 v243, v[24:27] offset:12288
    s_add_u32 s43, s42, 128
    s_cmp_eq_u32 s43, 896
    s_cselect_b32 s43, 0, s43
    s_mul_i32 s51, s43, 1344
    v_fma_f32 v4, v246, v12, -v4
    v_fma_f32 v5, v246, v13, -v5
    v_fma_f32 v6, v246, v14, -v6
    v_fma_f32 v7, v246, v15, -v7
    v_fma_f32 v8, v246, v16, -v8
    v_fma_f32 v9, v246, v17, -v9
    v_fma_f32 v10, v246, v18, -v10
    v_fma_f32 v11, v246, v19, -v11
    v_cvt_pk_bf16_f32 v20, v4, v5
    v_cvt_pk_bf16_f32 v21, v6, v7
    v_cvt_pk_bf16_f32 v22, v8, v9
    v_cvt_pk_bf16_f32 v23, v10, v11
    ds_write_b128 v243, v[20:23] offset:16384
    s_add_u32 s44, s43, 128
    s_cmp_eq_u32 s44, 896
    s_cselect_b32 s44, 0, s44
    s_mul_i32 s52, s44, 1344
    v_fma_f32 v12, v246, v4, -v12
    v_fma_f32 v13, v246, v5, -v13
    v_fma_f32 v14, v246, v6, -v14
    v_fma_f32 v15, v246, v7, -v15
    v_fma_f32 v16, v246, v8, -v16
    v_fma_f32 v17, v246, v9, -v17
    v_fma_f32 v18, v246, v10, -v18
    v_fma_f32 v19, v246, v11, -v19
    v_cvt_pk_bf16_f32 v24, v12, v13
    v_cvt_pk_bf16_f32 v25, v14, v15
    v_cvt_pk_bf16_f32 v26, v16, v17
    v_cvt_pk_bf16_f32 v27, v18, v19
    ds_write_b128 v243, v[24:27] offset:20480
    s_add_u32 s45, s44, 128
    s_cmp_eq_u32 s45, 896
    s_cselect_b32 s45, 0, s45
    s_mul_i32 s53, s45, 1344
    v_fma_f32 v4, v246, v12, -v4
    v_fma_f32 v5, v246, v13, -v5
    v_fma_f32 v6, v246, v14, -v6
    v_fma_f32 v7, v246, v15, -v7
    v_fma_f32 v8, v246, v16, -v8
    v_fma_f32 v9, v246, v17, -v9
    v_fma_f32 v10, v246, v18, -v10
    v_fma_f32 v11, v246, v19, -v11
    v_cvt_pk_bf16_f32 v20, v4, v5
    v_cvt_pk_bf16_f32 v21, v6, v7
    v_cvt_pk_bf16_f32 v22, v8, v9
    v_cvt_pk_bf16_f32 v23, v10, v11
    ds_write_b128 v243, v[20:23] offset:24576
    s_add_u32 s46, s45, 128
    s_cmp_eq_u32 s46, 896
    s_cselect_b32 s46, 0, s46
    s_mul_i32 s54, s46, 1344
    v_bfe_u32 v227, v0, 1, 3
    v_xor_b32 v227, v227, v217
    v_lshlrev_b32 v227, 4, v227
    v_lshl_add_u32 v227, v216, 7, v227
    v_add_u32 v68, s56, v227
    v_xor_b32 v69, 32, v68
    v_xor_b32 v70, 64, v68
    v_xor_b32 v71, 96, v68
    v_bfe_u32 v227, v0, 2, 2
    v_lshl_add_u32 v227, v217, 3, v227
    v_lshlrev_b32 v227, 6, v227
    v_and_b32 v226, 1, v214
    v_lshl_add_u32 v227, v226, 5, v227
    v_and_b32 v226, 3, v0
    v_lshl_add_u32 v227, v226, 3, v227
    v_add_u32 v210, 0x18000, v227
    s_add_u32 s38, s57, 0x1e000
    v_add_u32 v209, s38, v227
    v_mul_u32_u24 v227, 224, v217
    v_bfe_u32 v225, v0, 2, 1
    v_mad_u32_u24 v227, v225, 28, v227
    v_and_b32 v225, 24, v0
    v_add_u32 v227, v227, v225
    v_lshl_add_u32 v227, v226, 1, v227
    v_add_u32 v208, 0x26000, v227
    v_mov_b32 v100, 0
    v_mov_b32 v101, 0
    v_mov_b32 v102, 0
    v_mov_b32 v103, 0
    v_mov_b32 v104, 0
    v_mov_b32 v105, 0
    v_mov_b32 v106, 0
    v_mov_b32 v107, 0
    v_add_u32 v72, 0x10000, v68
    v_add_u32 v73, 0x10000, v69
    v_add_u32 v74, 0x10000, v70
    v_add_u32 v75, 0x10000, v71
    s_lshl2_add_u32 s68, s34, s32
    s_lshl_b32 s69, s68, 8
    s_add_u32 s69, s69, 0x60000
    v_and_b32 v207, 7, v0
    v_min_u32 v207, 6, v207
    v_lshl_add_u32 v195, v207, 5, s69
    s_mul_i32 s68, s68, 7168
    s_add_u32 s68, s68, 0x5ff400
    v_add_u32 v194, s68, v218
    v_add_u32 v193, 0x8000, v218
    s_mov_b32 s18, 0x62000
    s_mov_b32 s19, 0x20000
    s_mov_b32 s26, 0x1c0000
    s_mov_b32 s27, 0x20000
    s_mul_i32 s68, s64, 37
    s_lshr_b32 s68, s68, 8
    s_mul_i32 s69, s68, 7
    s_sub_u32 s60, s64, s69
    s_and_b32 s69, s2, 7
    s_lshl2_add_u32 s59, s69, s68
    s_and_b32 s62, s32, 1
    s_lshr_b32 s68, s32, 1
    s_lshl_b32 s63, s68, 5
    s_add_u32 s63, s63, s59
    s_mov_b32 s66, 0x3fb8aa3b
    v_mov_b32 v244, 0x3f803f80
    v_mov_b32 v245, 0x3f803f80
    v_mov_b32 v246, 0x3f803f80
    v_mov_b32 v247, 0x3f803f80
    s_add_u32 s68, s56, 0x8c00
    v_bfe_u32 v207, v0, 1, 1
    v_lshl_add_u32 v207, v207, 9, s68
    v_and_b32 v206, 1, v0
    v_lshl_add_u32 v207, v206, 6, v207
    v_bfe_u32 v206, v0, 2, 1
    v_lshl_add_u32 v192, v206, 15, v207
    v_cmp_lt_u32 vcc, 27, v216
    v_subrev_u32 v207, 4, v216
    s_nop 0
    v_cndmask_b32 v207, v216, v207, vcc
    v_mul_u32_u24 v206, 37, v207
    v_lshrrev_b32 v206, 8, v206
    v_mul_u32_u24 v205, 7, v206
    v_sub_u32 v207, v207, v205
    v_add_u32 v207, 1, v207
    v_and_b32 v205, 4, v207
    v_add_u32 v207, v207, v205
    v_and_b32 v205, 1, v206
    v_lshl_add_u32 v207, v205, 2, v207
    v_and_b32 v205, 2, v206
    v_lshl_add_u32 v207, v205, 3, v207
    s_mov_b32 exec_lo, 0x4000000
    s_mov_b32 exec_hi, 0x4000000
    v_mov_b32 v207, 16
    s_mov_b32 exec_lo, 0x8000000
    s_mov_b32 exec_hi, 0x8000000
    v_mov_b32 v207, 20
    s_mov_b64 exec, -1
    v_lshlrev_b32 v207, 4, v207
    v_lshl_add_u32 v207, v217, 9, v207
    v_add_u32 v191, s68, v207
    v_and_b32 v207, 7, v0
    v_xor_b32 v207, v207, v217
    v_lshlrev_b32 v207, 4, v207
    v_lshl_add_u32 v207, v216, 7, v207
    s_add_u32 s68, s56, 0x14000
    v_add_u32 v240, s68, v207
    v_xor_b32 v241, 32, v240
    v_xor_b32 v242, 64, v240
    v_xor_b32 v243, 96, v240
    v_bfe_u32 v206, v0, 2, 3
    v_lshl_add_u32 v205, v217, 4, v206
    v_bfe_u32 v204, v0, 1, 1
    s_lshl_b32 s69, s32, 1
    v_add_u32 v204, s69, v204
    v_xor_b32 v204, v204, v206
    v_lshlrev_b32 v204, 4, v204
    v_lshl_add_u32 v205, v205, 7, v204
    v_and_b32 v204, 1, v0
    v_lshl_add_u32 v205, v204, 3, v205
    v_add_u32 v190, 0x14000, v205
    v_lshlrev_b32 v203, 4, v215
    v_and_b32 v204, 1, v214
    v_lshl_add_u32 v204, v204, 9, v203
    v_lshl_add_u32 v204, v217, 15, v204
    v_add_u32 v189, 0x8c00, v204
    v_cvt_f32_u32 v207, v216
    v_mul_f32 v207, 0x3d000000, v207
    v_lshl_add_u32 v206, v217, 8, s58
    v_cvt_f32_u32 v206, v206
    v_mul_f32 v206, 0x3c800000, v206
    v_mul_f32 v206, v206, v207
    v_mov_b32 v205, v206
    v_fmamk_f32 v204, v207, 0x3f800000, v206
    v_cos_f32 v203, v205
    v_cos_f32 v202, v204
    v_sin_f32 v201, -v205
    v_sin_f32 v200, -v204
    v_cvt_pk_bf16_f32 v84, v203, v202
    v_cvt_pk_bf16_f32 v92, v201, v200
    v_fmamk_f32 v205, v207, 0x40000000, v206
    v_fmamk_f32 v204, v207, 0x40400000, v206
    v_cos_f32 v203, v205
    v_cos_f32 v202, v204
    v_sin_f32 v201, -v205
    v_sin_f32 v200, -v204
    v_cvt_pk_bf16_f32 v85, v203, v202
    v_cvt_pk_bf16_f32 v93, v201, v200
    v_bfe_i32 v207, v0, 0, 1
    v_bfe_i32 v206, v0, 1, 1
    v_and_b32 v205, 0x80008000, v207
    v_and_b32 v206, 0x80008000, v206
    v_xor_b32 v204, v206, v205
    v_bfi_b32 v203, v207, v92, v84
    v_bfi_b32 v202, v207, v84, v92
    v_xor_b32 v86, v203, v206
    v_xor_b32 v94, v202, v204
    v_xor_b32 v88, v84, v205
    v_xor_b32 v96, v92, v205
    v_xor_b32 v90, v86, v205
    v_xor_b32 v98, v94, v205
    v_bfi_b32 v203, v207, v93, v85
    v_bfi_b32 v202, v207, v85, v93
    v_xor_b32 v87, v203, v206
    v_xor_b32 v95, v202, v204
    v_xor_b32 v89, v85, v205
    v_xor_b32 v97, v93, v205
    v_xor_b32 v91, v87, v205
    v_xor_b32 v99, v95, v205
    s_add_u32 s68, s56, 2048
    v_lshl_add_u32 v188, v217, 4, s68
    v_lshl_add_u32 v187, v216, 2, s68
    v_bfe_u32 v207, v0, 1, 2
    v_xor_b32 v207, v207, v217
    v_lshlrev_b32 v207, 4, v207
    v_lshl_add_u32 v207, v216, 6, v207
    v_add_u32 v230, s56, v207
    v_xor_b32 v231, 32, v230
    v_bfe_u32 v206, v0, 2, 2
    v_xor_b32 v206, v206, v217
    v_lshlrev_b32 v206, 4, v206
    v_lshl_add_u32 v206, v214, 6, v206
    v_and_b32 v205, 3, v0
    v_lshl_add_u32 v206, v205, 2, v206
    s_lshl_b32 s68, s32, 9
    v_add_u32 v228, s68, v206
    s_movk_i32 s69, 0x100
    v_xad_u32 v229, v228, 32, s69
    v_lshlrev_b32 v204, 4, v215
    v_lshl_add_u32 v186, v214, 16, v204
    s_lshl_b32 s68, s33, 12
    s_lshl_b32 s69, s34, 16
    s_add_u32 s69, s69, s68
    s_add_u32 s69, s69, s57
    s_add_u32 s12, s69, 0x100000
    s_lshl_b32 s69, s32, 19
    s_add_u32 s68, s68, s69
    s_lshl_b32 s69, s34, 8
    s_add_u32 s68, s68, s69
    s_add_u32 s14, s68, 0x200000
    s_lshl_b32 s68, s32, 4
    s_add_u32 s68, s68, s34
    s_lshl_b32 s68, s68, 4
    s_add_u32 s68, s68, s33
    s_lshl_b32 s68, s68, 7
    s_add_u32 s15, s68, 0x40000
    s_lshl_b32 s68, s34, 16
    s_add_u32 s68, s68, s57
    s_add_u32 s13, s68, 0x100000
    s_lshl_b32 s68, s58, 15
    s_lshl_b32 s69, s34, 10
    s_add_u32 s68, s68, s69
    s_add_u32 s20, s68, 0x400000
    s_lshl1_add_u32 s68, s63, s62
    s_lshl_b32 s68, s68, 14
    s_add_u32 s23, s68, 0x400000
    s_lshl_b32 s68, s63, 7
    s_lshl_b32 s69, s62, 6
    s_add_u32 s68, s68, s69
    s_add_u32 s22, s68, 0x20000
    s_lshl_b32 s68, s62, 10
    s_add_u32 s68, s68, s63
    s_mul_i32 s68, s68, 896
    s_lshl_b32 s69, s60, 7
    s_add_u32 s36, s68, s69
    v_lshlrev_b32 v207, 4, v215
    v_lshl_add_u32 v206, v217, 9, v207
    v_and_b32 v205, 1, v214
    v_lshl_add_u32 v185, v205, 14, v206
    v_lshl_add_u32 v206, v205, 3, v206
    s_add_u32 s68, s56, 3072
    v_add_u32 v184, s68, v206
    v_lshl_add_u32 v207, v217, 8, v207
    v_lshl_add_u32 v183, v205, 14, v207
    v_and_b32 v207, 1, v0
    v_lshlrev_b32 v207, 4, v207
    s_movk_i32 s68, 0x3f80
    v_lshlrev_b32 v207, v207, s68
    v_bfe_u32 v206, v0, 1, 3
    v_lshlrev_b32 v205, 2, v217
    v_xor_b32 v206, v206, v205
    v_cmp_eq_u32 vcc, 0, v206
    s_nop 1
    v_cndmask_b32 v236, 0, v207, vcc
    v_cmp_eq_u32 vcc, 1, v206
    s_nop 1
    v_cndmask_b32 v237, 0, v207, vcc
    v_cmp_eq_u32 vcc, 2, v206
    s_nop 1
    v_cndmask_b32 v238, 0, v207, vcc
    s_waitcnt vmcnt(8)
    ds_read_b64_tr_b16 v[76:77], v209 offset:36864
    ds_read_b64_tr_b16 v[78:79], v209 offset:37120
    v_cmp_eq_u32 vcc, 3, v206
    s_nop 1
    v_cndmask_b32 v239, 0, v207, vcc
    v_lshrrev_b32 v207, 3, v0
    v_and_b32 v206, 1, v214
    s_and_b32 s68, s32, 1
    s_lshl_b32 s68, s68, 2
    v_lshl_or_b32 v206, v206, 1, s68
    v_xor_b32 v206, v206, v0
    v_and_b32 v206, 7, v206
    s_mul_i32 s68, s32, 6272
    s_lshl_b32 s69, s60, 7
    s_add_u32 s68, s68, s69
    v_lshl_add_u32 v206, v206, 4, s68
    v_subrev_u32 v207, 1, v207
    s_movk_i32 s68, 896
    v_mad_u32_u24 v182, v207, s68, v206
    s_waitcnt lgkmcnt(0)
    buffer_store_dwordx4 v[76:79], v218, s[28:31], s35 offen sc1
    s_mov_b32 exec_lo, 0xff
    s_mov_b32 exec_hi, 0x0
    v_mov_b32 v182, 0x40000000
    s_mov_b64 exec, -1
    s_cmp_ge_u32 s64, 28
    s_cselect_b32 s18, 0, s18
    s_lshl_b32 s68, s60, 6
    s_lshl_b32 s69, s32, 4
    s_add_u32 s68, s68, s69
    s_sub_u32 s1, 32, s59
    s_and_b32 s1, s1, 31
    s_sub_u32 s69, 448, s68
    s_cmp_ge_u32 s68, 224
    s_cselect_b32 s1, s1, s59
    s_cselect_b32 s68, s69, s68
    s_cselect_b32 s0, -1, 1
    s_add_u32 m0, s56, 0x4000
    s_nop 0
    buffer_load_dwordx4 v252, s[4:7], s41 offen offset:0 lds
    v_lshlrev_b32 v205, 3, v214
    v_min_u32 v205, 15, v205
    v_mul_i32_i24 v205, s0, v205
    v_add_u32 v205, s68, v205
    v_mul_u32_u24 v204, 4682, v205
    v_lshrrev_b32 v204, 16, v204
    v_min_u32 v204, 15, v204
    s_lshr_b32 s69, s1, 3
    s_lshl_b32 s69, s69, 15
    s_add_u32 s69, s69, 0x40000
    s_add_u32 m0, s56, 0x4000
    s_nop 0
    buffer_load_dwordx4 v253, s[4:7], s41 offen offset:1024 lds
    v_lshl_add_u32 v204, v204, 4, v215
    v_lshl_add_u32 v181, v204, 7, s69
    v_mul_i32_i24 v205, s0, v215
    v_add_u32 v205, s68, v205
    v_mul_u32_u24 v203, 4682, v205
    v_lshrrev_b32 v203, 16, v203
    v_min_u32 v203, 15, v203
    v_lshl_add_u32 v205, v203, 1, v205
    v_lshlrev_b32 v205, 4, v205
    v_lshl_add_u32 v180, v214, 12, v205
    s_add_u32 m0, s56, 0x4000
    s_nop 0
    buffer_load_dwordx4 v254, s[4:7], s41 offen offset:2048 lds
    s_lshl_b32 s68, s1, 16
    s_add_u32 s21, s68, 0x200000
    s_and_b32 s68, s63, 3
    s_lshl_b32 s68, s68, 8
    s_lshr_b32 s69, s63, 2
    s_add_u32 s68, s68, s69
    s_lshl_b32 s68, s68, 7
    s_add_u32 s68, s68, 0x40000
    s_mov_b32 exec_lo, 0x0
    s_mov_b32 exec_hi, 0xffff0000
    v_mov_b32 v181, s68
    s_mov_b64 exec, -1
    s_add_u32 m0, s56, 0x4000
    s_nop 0
    buffer_load_dwordx4 v255, s[4:7], s41 offen offset:3072 lds
    v_mul_u32_u24 v205, 0xe000, v215
    v_lshl_add_u32 v205, v217, 4, v205
    v_and_b32 v203, 1, v214
    v_lshl_add_u32 v3, v203, 5, v205
    v_bfe_u32 v205, v0, 2, 2
    v_lshlrev_b32 v205, 7, v205
    v_lshl_add_u32 v205, v214, 10, v205
    v_and_b32 v204, 3, v0
    v_lshl_add_u32 v205, v204, 3, v205
    v_bfe_u32 v204, v0, 3, 2
    s_add_u32 m0, s57, 0x19000
    s_nop 0
    buffer_load_dwordx4 v219, s[8:11], s49 offen sc1 lds
    s_add_u32 m0, s56, 0x8000
    s_nop 0
    buffer_load_dwordx4 v252, s[4:7], s42 offen offset:0 lds
    s_add_u32 m0, s56, 0x8000
    s_nop 0
    buffer_load_dwordx4 v253, s[4:7], s42 offen offset:1024 lds
    s_add_u32 m0, s56, 0x8000
    s_nop 0
    buffer_load_dwordx4 v254, s[4:7], s42 offen offset:2048 lds
    s_add_u32 m0, s56, 0x8000
    s_nop 0
    buffer_load_dwordx4 v255, s[4:7], s42 offen offset:3072 lds
    s_add_u32 m0, s57, 0x1a000
    s_nop 0
    buffer_load_dwordx4 v219, s[8:11], s50 offen sc1 lds
    s_add_u32 s37, s37, 0x9e3779b9
    s_and_b32 s61, s37, 0x9fff
    s_or_b32 s61, s61, 0x2000
    v_mov_b32 v197, s37
    v_mov_b32 v196, 0
    s_mov_b32 exec_lo, 0x3fff
    s_mov_b32 exec_hi, 0x0
    s_waitcnt vmcnt(12)
    ds_write_b128 v213, v[248:251]
    s_mov_b64 exec, -1
    s_waitcnt lgkmcnt(0)
    s_barrier
    ds_read_b64_tr_b16 a[112:113], v210 offset:0
    ds_read_b64_tr_b16 a[114:115], v210 offset:256
    ds_read_b128 a[0:3], v68 offset:0
    s_waitcnt vmcnt(10)
    s_mov_b32 exec_lo, 0x1
    s_mov_b32 exec_hi, 0x0
    buffer_store_dword v197, v196, s[28:31], s55 offen sc1
    s_mov_b64 exec, -1
    s_add_u32 m0, s56, 0xc000
    s_nop 0
    buffer_load_dwordx4 v252, s[4:7], s43 offen offset:0 lds
    ds_read_b64_tr_b16 a[116:117], v210 offset:1024
    ds_read_b64_tr_b16 a[118:119], v210 offset:1280
    ds_read_b128 a[4:7], v69 offset:0
    ds_read_b64_tr_b16 a[120:121], v210 offset:2048
    ds_read_b64_tr_b16 a[122:123], v210 offset:2304
    ds_read_b128 a[8:11], v70 offset:0
    s_add_u32 m0, s56, 0xc000
    s_nop 0
    buffer_load_dwordx4 v253, s[4:7], s43 offen offset:1024 lds
    ds_read_b64_tr_b16 a[124:125], v210 offset:3072
    ds_read_b64_tr_b16 a[126:127], v210 offset:3328
    ds_read_b128 a[12:15], v71 offset:0
    s_waitcnt lgkmcnt(9)
    v_mfma_f32_32x32x16_bf16 v[20:35], a[112:115], a[0:3], 0
    ds_read_b128 a[128:131], v212 offset:0
    s_add_u32 m0, s56, 0xc000
    s_nop 0
    buffer_load_dwordx4 v254, s[4:7], s43 offen offset:2048 lds
    ds_read_u16 v4, v208 offset:0
    ds_read_u16 v5, v208 offset:56
    ds_read_u16 v6, v208 offset:112
    ds_read_u16 v7, v208 offset:168
    s_waitcnt lgkmcnt(11)
    v_mfma_f32_32x32x16_bf16 v[20:35], a[116:119], a[4:7], v[20:35]
    ds_read_b128 a[132:135], v212 offset:1024
    ds_read_u16 v8, v208 offset:448
    ds_read_u16 v9, v208 offset:504
    ds_read_u16 v10, v208 offset:560
    ds_read_u16 v11, v208 offset:616
    s_waitcnt lgkmcnt(13)
    v_mfma_f32_32x32x16_bf16 v[20:35], a[120:123], a[8:11], v[20:35]
    ds_read_b128 a[136:139], v212 offset:2048
    s_add_u32 m0, s56, 0xc000
    s_nop 0
    buffer_load_dwordx4 v255, s[4:7], s43 offen offset:3072 lds
    ds_read_u16 v12, v208 offset:896
    ds_read_u16 v13, v208 offset:952
    ds_read_u16 v14, v208 offset:1008
    ds_read_u16 v15, v208 offset:1064
    s_waitcnt lgkmcnt(14)
    v_mfma_f32_32x32x16_bf16 v[20:35], a[124:127], a[12:15], v[20:35]
    ds_read_b128 a[140:143], v212 offset:3072
    ds_read_u16 v16, v208 offset:1120
    ds_read_u16 v17, v208 offset:1176
    ds_read_u16 v18, v208 offset:1232
    ds_read_u16 v19, v208 offset:1288
    v_lshl_add_u32 v205, v204, 5, v205
    v_add_u32 v232, 0x18000, v205
    v_xor_b32 v233, 32, v232
    v_xor_b32 v234, 64, v232
    v_xor_b32 v235, 96, v232
    s_add_u32 m0, s57, 0x1b000
    s_nop 0
    buffer_load_dwordx4 v219, s[8:11], s51 offen sc1 lds
    s_lshl_b32 s68, s62, 5
    s_lshr_b32 s69, s32, 1
    s_add_u32 s68, s68, s69
    s_cmp_lg_u32 s59, 0
    s_cselect_b32 s69, 1, 0
    v_lshl_add_u32 v223, v215, 1, s68
    v_add_u32 v222, s69, v223
    v_sub_u32 v222, 0, v222
    v_lshlrev_b32 v221, 2, v214
    v_cvt_f32_u32 v221, v221
    s_waitcnt vmcnt(12)
    s_waitcnt vmcnt(11)
    s_waitcnt lgkmcnt(0)
    s_barrier
    ds_read_b64_tr_b16 a[112:113], v210 offset:4096
    ds_read_b64_tr_b16 a[114:115], v210 offset:4352
    ds_read_b128 a[16:19], v68 offset:16384
    v_mfma_f32_32x32x16_bf16 v[36:51], a[0:3], a[128:131], 0
    s_cmp_ge_u32 s60, 4
    s_cselect_b64 vcc, -1, 0
    v_cndmask_b32 v205, v223, v222, vcc
    s_add_u32 m0, s56, 0x10000
    s_nop 0
    buffer_load_dwordx4 v252, s[4:7], s44 offen offset:0 lds
    ds_read_b64_tr_b16 a[116:117], v210 offset:5120
    ds_read_b64_tr_b16 a[118:119], v210 offset:5376
    ds_read_b128 a[20:23], v69 offset:16384
    v_mfma_f32_32x32x16_bf16 v[36:51], a[4:7], a[132:135], v[36:51]
    v_cvt_f32_i32 v207, v205
    ds_read_b64_tr_b16 a[120:121], v210 offset:6144
    ds_read_b64_tr_b16 a[122:123], v210 offset:6400
    ds_read_b128 a[24:27], v70 offset:16384
    v_mfma_f32_32x32x16_bf16 v[36:51], a[8:11], a[136:139], v[36:51]
    v_mul_f32 v207, 0x3c800000, v207
    s_add_u32 m0, s56, 0x10000
    s_nop 0
    buffer_load_dwordx4 v253, s[4:7], s44 offen offset:1024 lds
    ds_read_b64_tr_b16 a[124:125], v210 offset:7168
    ds_read_b64_tr_b16 a[126:127], v210 offset:7424
    ds_read_b128 a[28:31], v71 offset:16384
    v_mfma_f32_32x32x16_bf16 v[36:51], a[12:15], a[140:143], v[36:51]
    v_mul_f32 v206, v207, v221
    s_waitcnt lgkmcnt(9)
    v_mfma_f32_32x32x16_bf16 v[20:35], a[112:115], a[16:19], v[20:35]
    ds_read_b128 a[128:131], v212 offset:4096
    s_add_u32 m0, s56, 0x10000
    s_nop 0
    buffer_load_dwordx4 v254, s[4:7], s44 offen offset:2048 lds
    s_mov_b32 exec_lo, 0x33ffffff
    s_mov_b32 exec_hi, 0x33ffffff
    v_lshl_or_b32 v100, v5, 16, v4
    v_lshl_or_b32 v101, v7, 16, v6
    v_lshl_or_b32 v102, v9, 16, v8
    v_lshl_or_b32 v103, v11, 16, v10
    v_lshl_or_b32 v104, v13, 16, v12
    v_lshl_or_b32 v105, v15, 16, v14
    s_mov_b32 exec_lo, 0
    v_lshl_or_b32 v106, v17, 16, v16
    v_lshl_or_b32 v107, v19, 16, v18
    s_mov_b64 exec, -1
    s_waitcnt lgkmcnt(7)
    v_mfma_f32_32x32x16_bf16 v[20:35], a[116:119], a[20:23], v[20:35]
    ds_read_b128 a[132:135], v212 offset:5120
    v_mov_b32 v202, v206
    v_cos_f32 v201, v202
    s_waitcnt lgkmcnt(5)
    v_mfma_f32_32x32x16_bf16 v[20:35], a[120:123], a[24:27], v[20:35]
    ds_read_b128 a[136:139], v212 offset:6144
    s_add_u32 m0, s56, 0x10000
    s_nop 0
    buffer_load_dwordx4 v255, s[4:7], s44 offen offset:3072 lds
    v_sin_f32 v200, v202
    s_waitcnt lgkmcnt(3)
    v_mfma_f32_32x32x16_bf16 v[20:35], a[124:127], a[28:31], v[20:35]
    ds_read_b128 a[140:143], v212 offset:7168
    v_cvt_pk_bf16_f32 v132, v201, v200
    v_fmamk_f32 v202, v207, 0x3f800000, v206
    v_cos_f32 v201, v202
    v_sin_f32 v200, v202
    s_nop 0
    v_cvt_pk_bf16_f32 v133, v201, v200
    v_fmamk_f32 v202, v207, 0x40000000, v206
    v_cos_f32 v201, v202
    s_add_u32 m0, s57, 0x1c000
    s_nop 0
    buffer_load_dwordx4 v219, s[8:11], s52 offen sc1 lds
    v_sin_f32 v200, v202
    s_nop 0
    v_cvt_pk_bf16_f32 v134, v201, v200
    v_fmamk_f32 v202, v207, 0x40400000, v206
    v_cos_f32 v201, v202
    v_sin_f32 v200, v202
    s_nop 0
    v_cvt_pk_bf16_f32 v135, v201, v200
    v_bfe_i32 v207, v205, 0, 1
    v_bfe_i32 v206, v205, 1, 1
    s_waitcnt vmcnt(12)
    s_waitcnt vmcnt(11)
    s_waitcnt lgkmcnt(0)
    s_barrier
    ds_read_b64_tr_b16 a[112:113], v210 offset:8192
    ds_read_b64_tr_b16 a[114:115], v210 offset:8448
    ds_read_b128 a[32:35], v68 offset:32768
    v_mfma_f32_32x32x16_bf16 v[36:51], a[16:19], a[128:131], v[36:51]
    v_and_b32 v204, 16, v207
    buffer_load_dword v227, v195, s[28:31], 0 offen sc1
    ds_read_b64_tr_b16 a[116:117], v210 offset:9216
    ds_read_b64_tr_b16 a[118:119], v210 offset:9472
    ds_read_b128 a[36:39], v69 offset:32768
    v_mfma_f32_32x32x16_bf16 v[36:51], a[20:23], a[132:135], v[36:51]
    v_and_b32 v203, 0x8000, v207
    s_add_u32 m0, s56, 0x14000
    s_nop 0
    buffer_load_dwordx4 v252, s[4:7], s45 offen offset:0 lds
    ds_read_b64_tr_b16 a[120:121], v210 offset:10240
    ds_read_b64_tr_b16 a[122:123], v210 offset:10496
    ds_read_b128 a[40:43], v70 offset:32768
    v_mfma_f32_32x32x16_bf16 v[36:51], a[24:27], a[136:139], v[36:51]
    v_and_b32 v207, 0x80008000, v207
    s_add_u32 m0, s56, 0x14000
    s_nop 0
    buffer_load_dwordx4 v253, s[4:7], s45 offen offset:1024 lds
    ds_read_b64_tr_b16 a[124:125], v210 offset:11264
    ds_read_b64_tr_b16 a[126:127], v210 offset:11520
    ds_read_b128 a[44:47], v71 offset:32768
    v_mfma_f32_32x32x16_bf16 v[36:51], a[28:31], a[140:143], v[36:51]
    v_and_b32 v206, 0x80008000, v206
    s_waitcnt lgkmcnt(9)
    v_mfma_f32_32x32x16_bf16 v[20:35], a[112:115], a[32:35], v[20:35]
    ds_read_b128 a[128:131], v212 offset:8192
    s_add_u32 m0, s56, 0x14000
    s_nop 0
    buffer_load_dwordx4 v254, s[4:7], s45 offen offset:2048 lds
    v_xor_b32 v206, v206, v203
    s_waitcnt lgkmcnt(7)
    v_mfma_f32_32x32x16_bf16 v[20:35], a[116:119], a[36:39], v[20:35]
    ds_read_b128 a[132:135], v212 offset:9216
    v_alignbit_b32 v202, v132, v132, v204
    v_xor_b32 v140, v132, v207
    v_xor_b32 v136, v202, v206
    s_waitcnt lgkmcnt(5)
    v_mfma_f32_32x32x16_bf16 v[20:35], a[120:123], a[40:43], v[20:35]
    ds_read_b128 a[136:139], v212 offset:10240
    s_add_u32 m0, s56, 0x14000
    s_nop 0
    buffer_load_dwordx4 v255, s[4:7], s45 offen offset:3072 lds
    v_xor_b32 v144, v136, v207
    s_waitcnt lgkmcnt(3)
    v_mfma_f32_32x32x16_bf16 v[20:35], a[124:127], a[44:47], v[20:35]
    ds_read_b128 a[140:143], v212 offset:11264
    v_alignbit_b32 v202, v133, v133, v204
    v_xor_b32 v141, v133, v207
    v_xor_b32 v137, v202, v206
    v_xor_b32 v145, v137, v207
    v_alignbit_b32 v202, v134, v134, v204
    v_xor_b32 v142, v134, v207
    v_xor_b32 v138, v202, v206
    v_xor_b32 v146, v138, v207
    s_add_u32 m0, s57, 0x1d000
    s_nop 0
    buffer_load_dwordx4 v219, s[8:11], s53 offen sc1 lds
    v_alignbit_b32 v202, v135, v135, v204
    v_xor_b32 v143, v135, v207
    v_xor_b32 v139, v202, v206
    v_xor_b32 v147, v139, v207
    s_cmp_ge_u32 s60, 3
    s_cselect_b64 vcc, -1, 0
    v_cndmask_b32 v205, v223, v222, vcc
    v_cvt_f32_i32 v207, v205
    v_mul_f32 v207, 0x3c800000, v207
    v_mul_f32 v206, v207, v221
    v_mov_b32 v202, v206
    v_cos_f32 v201, v202
    s_waitcnt vmcnt(12)
    s_waitcnt vmcnt(11)
    s_waitcnt lgkmcnt(0)
    s_barrier
    ds_read_b64_tr_b16 a[112:113], v210 offset:12288
    ds_read_b64_tr_b16 a[114:115], v210 offset:12544
    ds_read_b128 a[48:51], v68 offset:49152
    v_mfma_f32_32x32x16_bf16 v[36:51], a[32:35], a[128:131], v[36:51]
    v_sin_f32 v200, v202
    s_add_u32 m0, s56, 0x0
    s_nop 0
    buffer_load_dwordx4 v252, s[4:7], s46 offen offset:0 lds
    ds_read_b64_tr_b16 a[116:117], v210 offset:13312
    ds_read_b64_tr_b16 a[118:119], v210 offset:13568
    ds_read_b128 a[52:55], v69 offset:49152
    v_mfma_f32_32x32x16_bf16 v[36:51], a[36:39], a[132:135], v[36:51]
    v_cvt_pk_bf16_f32 v148, v201, v200
    s_add_u32 m0, s56, 0x0
    s_nop 0
    buffer_load_dwordx4 v253, s[4:7], s46 offen offset:1024 lds
    ds_read_b64_tr_b16 a[120:121], v210 offset:14336
    ds_read_b64_tr_b16 a[122:123], v210 offset:14592
    ds_read_b128 a[56:59], v70 offset:49152
    v_mfma_f32_32x32x16_bf16 v[36:51], a[40:43], a[136:139], v[36:51]
    v_fmamk_f32 v202, v207, 0x3f800000, v206
    s_add_u32 m0, s56, 0x0
    s_nop 0
    buffer_load_dwordx4 v254, s[4:7], s46 offen offset:2048 lds
    ds_read_b64_tr_b16 a[124:125], v210 offset:15360
    ds_read_b64_tr_b16 a[126:127], v210 offset:15616
    ds_read_b128 a[60:63], v71 offset:49152
    v_mfma_f32_32x32x16_bf16 v[36:51], a[44:47], a[140:143], v[36:51]
    v_cos_f32 v201, v202
    s_waitcnt lgkmcnt(9)
    v_mfma_f32_32x32x16_bf16 v[20:35], a[112:115], a[48:51], v[20:35]
    ds_read_b128 a[128:131], v212 offset:12288
    s_add_u32 m0, s56, 0x0
    s_nop 0
    buffer_load_dwordx4 v255, s[4:7], s46 offen offset:3072 lds
    v_sin_f32 v200, v202
    s_waitcnt lgkmcnt(7)
    v_mfma_f32_32x32x16_bf16 v[20:35], a[116:119], a[52:55], v[20:35]
    ds_read_b128 a[132:135], v212 offset:13312
    v_cvt_pk_bf16_f32 v149, v201, v200
    v_fmamk_f32 v202, v207, 0x40000000, v206
    v_cos_f32 v201, v202
    s_waitcnt lgkmcnt(5)
    v_mfma_f32_32x32x16_bf16 v[20:35], a[120:123], a[56:59], v[20:35]
    ds_read_b128 a[136:139], v212 offset:14336
    s_add_u32 m0, s57, 0x1e000
    s_nop 0
    buffer_load_dwordx4 v219, s[8:11], s54 offen sc1 lds
    v_sin_f32 v200, v202
    s_waitcnt lgkmcnt(3)
    v_mfma_f32_32x32x16_bf16 v[20:35], a[124:127], a[60:63], v[20:35]
    ds_read_b128 a[140:143], v212 offset:15360
    v_cvt_pk_bf16_f32 v150, v201, v200
    v_fmamk_f32 v202, v207, 0x40400000, v206
    v_cos_f32 v201, v202
    v_sin_f32 v200, v202
    s_nop 0
    v_cvt_pk_bf16_f32 v151, v201, v200
    v_bfe_i32 v207, v205, 0, 1
    v_bfe_i32 v206, v205, 1, 1
    s_mov_b32 s38, 0x4000
    buffer_load_dword v226, v195, s[28:31], s38 offen sc1
    v_and_b32 v204, 16, v207
    v_and_b32 v203, 0x8000, v207
    v_and_b32 v207, 0x80008000, v207
    v_and_b32 v206, 0x80008000, v206
    v_xor_b32 v206, v206, v203
    v_alignbit_b32 v202, v148, v148, v204
    v_xor_b32 v156, v148, v207
    v_xor_b32 v152, v202, v206
    v_xor_b32 v160, v152, v207
    v_alignbit_b32 v202, v149, v149, v204
    s_waitcnt vmcnt(13)
    s_waitcnt vmcnt(12)
    s_waitcnt lgkmcnt(0)
    s_barrier
    ds_read_b64_tr_b16 a[112:113], v210 offset:16384
    ds_read_b64_tr_b16 a[114:115], v210 offset:16640
    ds_read_b128 a[64:67], v72 offset:0
    v_mfma_f32_32x32x16_bf16 v[36:51], a[48:51], a[128:131], v[36:51]
    v_xor_b32 v157, v149, v207
    s_waitcnt vmcnt(11)
    v_cmp_ne_u32 vcc, s37, v227
    s_cbranch_vccz .Lr_okv
    s_mov_b32 s65, 0x8000
    s_mov_b32 s38, 0x0
.Lr_pollv:
    buffer_load_dword v227, v195, s[28:31], s38 offen sc1
    s_waitcnt vmcnt(0)
    v_cmp_ne_u32 vcc, s37, v227
    s_cbranch_vccz .Lr_okv
    s_sub_u32 s65, s65, 1
    s_cbranch_scc0 .Lr_pollv
.Lr_okv:
    s_add_u32 m0, s56, 0x4000
    s_lshl3_add_u32 s48, s40, 3072
    buffer_load_dwordx4 v194, s[28:31], s48 offen offset:0 sc1 lds
    ds_read_b64_tr_b16 a[116:117], v210 offset:17408
    ds_read_b64_tr_b16 a[118:119], v210 offset:17664
    ds_read_b128 a[68:71], v73 offset:0
    v_mfma_f32_32x32x16_bf16 v[36:51], a[52:55], a[132:135], v[36:51]
    v_xor_b32 v153, v202, v206
    s_add_u32 m0, s56, 0x4000
    s_lshl3_add_u32 s49, s41, 2048
    buffer_load_dwordx4 v194, s[28:31], s49 offen offset:1024 sc1 lds
    ds_read_b64_tr_b16 a[120:121], v210 offset:18432
    ds_read_b64_tr_b16 a[122:123], v210 offset:18688
    ds_read_b128 a[72:75], v74 offset:0
    v_mfma_f32_32x32x16_bf16 v[36:51], a[56:59], a[136:139], v[36:51]
    v_xor_b32 v161, v153, v207
    s_add_u32 m0, s56, 0x4000
    s_lshl3_add_u32 s50, s42, 1024
    buffer_load_dwordx4 v194, s[28:31], s50 offen offset:2048 sc1 lds
    ds_read_b64_tr_b16 a[124:125], v210 offset:19456
    ds_read_b64_tr_b16 a[126:127], v210 offset:19712
    ds_read_b128 a[76:79], v75 offset:0
    v_mfma_f32_32x32x16_bf16 v[36:51], a[60:63], a[140:143], v[36:51]
    v_alignbit_b32 v202, v150, v150, v204
    s_waitcnt lgkmcnt(9)
    v_mfma_f32_32x32x16_bf16 v[20:35], a[112:115], a[64:67], v[20:35]
    ds_read_b128 a[128:131], v212 offset:16384
    s_add_u32 m0, s56, 0x4000
    s_lshl3_add_u32 s51, s43, 0
    buffer_load_dwordx4 v194, s[28:31], s51 offen offset:3072 sc1 lds
    v_xor_b32 v158, v150, v207
    s_waitcnt lgkmcnt(7)
    v_mfma_f32_32x32x16_bf16 v[20:35], a[116:119], a[68:71], v[20:35]
    ds_read_b128 a[132:135], v212 offset:17408
    s_add_u32 m0, s56, 0x8000
    s_lshl3_add_u32 s52, s44, 3072
    buffer_load_dwordx4 v194, s[28:31], s52 offen offset:0 sc1 lds
    v_xor_b32 v154, v202, v206
    s_waitcnt lgkmcnt(5)
    v_mfma_f32_32x32x16_bf16 v[20:35], a[120:123], a[72:75], v[20:35]
    ds_read_b128 a[136:139], v212 offset:18432
    s_add_u32 m0, s56, 0x8000
    s_lshl3_add_u32 s53, s45, 2048
    buffer_load_dwordx4 v194, s[28:31], s53 offen offset:1024 sc1 lds
    v_xor_b32 v162, v154, v207
    s_waitcnt lgkmcnt(3)
    v_mfma_f32_32x32x16_bf16 v[20:35], a[124:127], a[76:79], v[20:35]
    ds_read_b128 a[140:143], v212 offset:19456
    v_alignbit_b32 v202, v151, v151, v204
    v_xor_b32 v159, v151, v207
    v_xor_b32 v155, v202, v206
    v_xor_b32 v163, v155, v207
    v_mov_b32 v199, s61
    v_lshlrev_b32 v198, 16, v199
    s_add_u32 m0, s56, 0x8000
    s_lshl3_add_u32 s54, s46, 1024
    buffer_load_dwordx4 v194, s[28:31], s54 offen offset:2048 sc1 lds
    s_waitcnt vmcnt(14)
    s_waitcnt vmcnt(13)
    s_waitcnt lgkmcnt(0)
    s_barrier
    ds_read_b64_tr_b16 a[112:113], v210 offset:20480
    ds_read_b64_tr_b16 a[114:115], v210 offset:20736
    ds_read_b128 a[80:83], v72 offset:16384
    v_mfma_f32_32x32x16_bf16 v[36:51], a[64:67], a[128:131], v[36:51]
    s_waitcnt vmcnt(7)
    v_cmp_ne_u32 vcc, s37, v226
    s_cbranch_vccz .Lr_okq
    s_mov_b32 s65, 0x8000
    s_mov_b32 s38, 0x4000
.Lr_pollq:
    buffer_load_dword v226, v195, s[28:31], s38 offen sc1
    s_waitcnt vmcnt(0)
    v_cmp_ne_u32 vcc, s37, v226
    s_cbranch_vccz .Lr_okq
    s_sub_u32 s65, s65, 1
    s_cbranch_scc0 .Lr_pollq
.Lr_okq:
    v_add_u32 v194, 0x70000, v194
    s_add_u32 m0, s56, 0xc000
    s_nop 0
    buffer_load_dwordx4 v194, s[28:31], s48 offen offset:0 sc1 lds
    ds_read_b64_tr_b16 a[116:117], v210 offset:21504
    ds_read_b64_tr_b16 a[118:119], v210 offset:21760
    ds_read_b128 a[84:87], v73 offset:16384
    v_mfma_f32_32x32x16_bf16 v[36:51], a[68:71], a[132:135], v[36:51]
    s_add_u32 m0, s56, 0xc000
    s_nop 0
    buffer_load_dwordx4 v194, s[28:31], s49 offen offset:1024 sc1 lds
    ds_read_b64_tr_b16 a[120:121], v210 offset:22528
    ds_read_b64_tr_b16 a[122:123], v210 offset:22784
    ds_read_b128 a[88:91], v74 offset:16384
    v_mfma_f32_32x32x16_bf16 v[36:51], a[72:75], a[136:139], v[36:51]
    s_add_u32 m0, s56, 0xc000
    s_nop 0
    buffer_load_dwordx4 v194, s[28:31], s50 offen offset:2048 sc1 lds
    ds_read_b64_tr_b16 a[124:125], v210 offset:23552
    ds_read_b64_tr_b16 a[126:127], v210 offset:23808
    ds_read_b128 a[92:95], v75 offset:16384
    v_mfma_f32_32x32x16_bf16 v[36:51], a[76:79], a[140:143], v[36:51]
    s_waitcnt lgkmcnt(9)
    v_mfma_f32_32x32x16_bf16 v[20:35], a[112:115], a[80:83], v[20:35]
    ds_read_b128 a[128:131], v212 offset:20480
    s_add_u32 m0, s56, 0xc000
    s_nop 0
    buffer_load_dwordx4 v194, s[28:31], s51 offen offset:3072 sc1 lds
    s_mov_b32 exec_lo, 0xff
    s_mov_b32 exec_hi, 0x0
    ds_write_b128 v192, v[244:247]
    s_mov_b64 exec, -1
    s_waitcnt lgkmcnt(8)
    v_mfma_f32_32x32x16_bf16 v[20:35], a[116:119], a[84:87], v[20:35]
    ds_read_b128 a[132:135], v212 offset:21504
    s_add_u32 m0, s56, 0x10000
    s_nop 0
    buffer_load_dwordx4 v194, s[28:31], s52 offen offset:0 sc1 lds
    s_waitcnt lgkmcnt(6)
    v_mfma_f32_32x32x16_bf16 v[20:35], a[120:123], a[88:91], v[20:35]
    ds_read_b128 a[136:139], v212 offset:22528
    s_add_u32 m0, s56, 0x10000
    s_nop 0
    buffer_load_dwordx4 v194, s[28:31], s53 offen offset:1024 sc1 lds
    s_waitcnt lgkmcnt(4)
    v_mfma_f32_32x32x16_bf16 v[20:35], a[124:127], a[92:95], v[20:35]
    ds_read_b128 a[140:143], v212 offset:23552
    s_add_u32 m0, s56, 0x10000
    s_nop 0
    buffer_load_dwordx4 v194, s[28:31], s54 offen offset:2048 sc1 lds
    s_waitcnt lgkmcnt(0)
    s_barrier
    ds_read_b64_tr_b16 a[112:113], v210 offset:24576
    ds_read_b64_tr_b16 a[114:115], v210 offset:24832
    ds_read_b128 a[96:99], v68 offset:0
    v_mfma_f32_32x32x16_bf16 v[36:51], a[80:83], a[128:131], v[36:51]
    s_lshl2_add_u32 s38, s64, s32
    s_mul_i32 s38, s38, 3584
    v_lshlrev_b32 v211, 6, v0
    buffer_load_dword v211, v211, s[16:19], s38 offen
    ds_read_b64_tr_b16 a[116:117], v210 offset:25600
    ds_read_b64_tr_b16 a[118:119], v210 offset:25856
    ds_read_b128 a[100:103], v69 offset:0
    v_mfma_f32_32x32x16_bf16 v[36:51], a[84:87], a[132:135], v[36:51]
    ds_read_b64_tr_b16 a[120:121], v210 offset:26624
    ds_read_b64_tr_b16 a[122:123], v210 offset:26880
    ds_read_b128 a[104:107], v70 offset:0
    v_mfma_f32_32x32x16_bf16 v[36:51], a[88:91], a[136:139], v[36:51]
    ds_read_b64_tr_b16 a[124:125], v210 offset:27648
    ds_read_b64_tr_b16 a[126:127], v210 offset:27904
    ds_read_b128 a[108:111], v71 offset:0
    v_mfma_f32_32x32x16_bf16 v[36:51], a[92:95], a[140:143], v[36:51]
    v_add_u32 v210, 0x18000, v218
    s_waitcnt lgkmcnt(9)
    v_mfma_f32_32x32x16_bf16 v[20:35], a[112:115], a[96:99], v[20:35]
    ds_read_b128 a[128:131], v212 offset:24576
    s_waitcnt lgkmcnt(7)
    v_mfma_f32_32x32x16_bf16 v[20:35], a[116:119], a[100:103], v[20:35]
    ds_read_b128 a[132:135], v212 offset:25600
    s_waitcnt lgkmcnt(5)
    v_mfma_f32_32x32x16_bf16 v[20:35], a[120:123], a[104:107], v[20:35]
    ds_read_b128 a[136:139], v212 offset:26624
    s_waitcnt lgkmcnt(3)
    v_mfma_f32_32x32x16_bf16 v[20:35], a[124:127], a[108:111], v[20:35]
    ds_read_b128 a[140:143], v212 offset:27648
    s_waitcnt lgkmcnt(3)
    v_mfma_f32_32x32x16_bf16 v[36:51], a[96:99], a[128:131], v[36:51]
    s_nop 8
    v_cvt_pk_bf16_f32 v108, v20, v21
    v_cvt_pk_bf16_f32 v109, v22, v23
    v_cvt_pk_bf16_f32 v110, v24, v25
    v_cvt_pk_bf16_f32 v111, v26, v27
    s_nop 1
    v_mfma_f32_32x32x16_bf16 v[52:67], v[100:103], v[108:111], 0
    v_cvt_pk_bf16_f32 v112, v28, v29
    v_cvt_pk_bf16_f32 v113, v30, v31
    v_cvt_pk_bf16_f32 v114, v32, v33
    v_cvt_pk_bf16_f32 v115, v34, v35
    s_nop 1
    v_mfma_f32_32x32x16_bf16 v[52:67], v[104:107], v[112:115], v[52:67]
    s_waitcnt lgkmcnt(2)
    v_mfma_f32_32x32x16_bf16 v[36:51], a[100:103], a[132:135], v[36:51]
    s_waitcnt lgkmcnt(1)
    v_mfma_f32_32x32x16_bf16 v[36:51], a[104:107], a[136:139], v[36:51]
    buffer_load_dword v211, v218, s[28:31], s12 offen offset:0
    buffer_load_dword v211, v183, s[28:31], s20 offen offset:0
    buffer_load_dword v211, v183, s[28:31], s20 offen offset:512
    buffer_load_dword v211, v196, s[28:31], s15 offen offset:4
    s_waitcnt vmcnt(12)
    s_waitcnt lgkmcnt(0)
    s_barrier
    v_mfma_f32_32x32x16_bf16 v[36:51], a[108:111], a[140:143], v[36:51]
    ds_read_b128 a[192:195], v218 offset:16384
    v_max3_f32 v254, v52, v53, v54
    v_min3_f32 v252, v52, v53, v54
    ds_read_b128 a[196:199], v218 offset:20480
    v_max3_f32 v254, v254, v55, v56
    v_min3_f32 v252, v252, v55, v56
    ds_read_b128 a[200:203], v218 offset:24576
    v_max3_f32 v254, v254, v57, v58
    v_min3_f32 v252, v252, v57, v58
    ds_read_b128 a[204:207], v218 offset:28672
    v_max3_f32 v254, v254, v59, v60
    v_min3_f32 v252, v252, v59, v60
    ds_read_b128 a[208:211], v218 offset:17408
    v_max3_f32 v254, v254, v61, v62
    v_min3_f32 v252, v252, v61, v62
    ds_read_b128 a[212:215], v218 offset:21504
    v_max3_f32 v254, v254, v63, v64
    v_min3_f32 v252, v252, v63, v64
    ds_read_b128 a[216:219], v218 offset:25600
    v_max_f32 v254, v254, v65
    v_max_f32_e64 v252, -v252, -v65
    ds_read_b128 a[220:223], v218 offset:29696
    s_nop 0
    v_permlane32_swap_b32 v254, v252
    v_max_f32 v254, v254, v252
    s_waitcnt lgkmcnt(4)
    v_mfma_f32_32x32x16_bf16 v[20:35], a[0:3], a[192:195], 0
    ds_read_b128 a[224:227], v218 offset:18432
    v_mul_f32 v254, 0xbfb8aa3b, v254
    v_mov_b32 v252, v254
    s_nop 1
    v_permlane32_swap_b32 v254, v252
    v_fma_f32 v68, v52, s66, v254
    v_fma_f32 v52, -v52, s66, v252
    v_fma_f32 v69, v53, s66, v254
    v_mfma_f32_32x32x16_bf16 v[20:35], a[4:7], a[196:199], v[20:35]
    ds_read_b128 a[228:231], v218 offset:22528
    v_fma_f32 v53, -v53, s66, v252
    v_fma_f32 v70, v54, s66, v254
    v_fma_f32 v54, -v54, s66, v252
    v_fma_f32 v71, v55, s66, v254
    v_fma_f32 v55, -v55, s66, v252
    v_fma_f32 v72, v56, s66, v254
    v_mfma_f32_32x32x16_bf16 v[20:35], a[8:11], a[200:203], v[20:35]
    ds_read_b128 a[232:235], v218 offset:26624
    v_fma_f32 v56, -v56, s66, v252
    v_fma_f32 v73, v57, s66, v254
    v_fma_f32 v57, -v57, s66, v252
    v_fma_f32 v74, v58, s66, v254
    v_fma_f32 v58, -v58, s66, v252
    v_fma_f32 v75, v59, s66, v254
    v_mfma_f32_32x32x16_bf16 v[20:35], a[12:15], a[204:207], v[20:35]
    ds_read_b128 a[236:239], v218 offset:30720
    v_fma_f32 v59, -v59, s66, v252
    v_fma_f32 v76, v60, s66, v254
    v_fma_f32 v60, -v60, s66, v252
    v_fma_f32 v77, v61, s66, v254
    v_fma_f32 v61, -v61, s66, v252
    v_fma_f32 v78, v62, s66, v254
    s_waitcnt lgkmcnt(4)
    v_mfma_f32_32x32x16_bf16 v[20:35], a[16:19], a[208:211], v[20:35]
    ds_read_b128 a[240:243], v218 offset:19456
    v_fma_f32 v62, -v62, s66, v252
    v_fma_f32 v79, v63, s66, v254
    v_fma_f32 v63, -v63, s66, v252
    v_fma_f32 v80, v64, s66, v254
    v_fma_f32 v64, -v64, s66, v252
    v_fma_f32 v81, v65, s66, v254
    v_mfma_f32_32x32x16_bf16 v[20:35], a[20:23], a[212:215], v[20:35]
    ds_read_b128 a[244:247], v218 offset:23552
    v_fma_f32 v65, -v65, s66, v252
    v_exp_f32 v68, v68
    v_exp_f32 v52, v52
    v_exp_f32 v69, v69
    v_mfma_f32_32x32x16_bf16 v[20:35], a[24:27], a[216:219], v[20:35]
    ds_read_b128 a[248:251], v218 offset:27648
    v_exp_f32 v53, v53
    v_exp_f32 v70, v70
    v_exp_f32 v54, v54
    v_mfma_f32_32x32x16_bf16 v[20:35], a[28:31], a[220:223], v[20:35]
    ds_read_b128 a[252:255], v218 offset:31744
    v_exp_f32 v71, v71
    v_exp_f32 v55, v55
    v_exp_f32 v72, v72
    s_waitcnt lgkmcnt(4)
    v_mfma_f32_32x32x16_bf16 v[20:35], a[32:35], a[224:227], v[20:35]
    ds_read_b128 a[192:195], v218 offset:32768
    v_exp_f32 v56, v56
    v_exp_f32 v73, v73
    v_exp_f32 v57, v57
    v_mfma_f32_32x32x16_bf16 v[20:35], a[36:39], a[228:231], v[20:35]
    ds_read_b128 a[196:199], v218 offset:36864
    v_exp_f32 v74, v74
    v_exp_f32 v58, v58
    v_exp_f32 v75, v75
    v_mfma_f32_32x32x16_bf16 v[20:35], a[40:43], a[232:235], v[20:35]
    ds_read_b128 a[200:203], v218 offset:40960
    v_exp_f32 v59, v59
    v_exp_f32 v76, v76
    v_exp_f32 v60, v60
    v_mfma_f32_32x32x16_bf16 v[20:35], a[44:47], a[236:239], v[20:35]
    ds_read_b128 a[204:207], v218 offset:45056
    v_exp_f32 v77, v77
    v_exp_f32 v61, v61
    v_exp_f32 v78, v78
    s_waitcnt lgkmcnt(4)
    v_mfma_f32_32x32x16_bf16 v[20:35], a[48:51], a[240:243], v[20:35]
    ds_read_b128 a[208:211], v218 offset:33792
    v_exp_f32 v62, v62
    v_exp_f32 v79, v79
    v_exp_f32 v63, v63
    v_mfma_f32_32x32x16_bf16 v[20:35], a[52:55], a[244:247], v[20:35]
    ds_read_b128 a[212:215], v218 offset:37888
    v_exp_f32 v80, v80
    v_exp_f32 v64, v64
    v_exp_f32 v81, v81
    v_mfma_f32_32x32x16_bf16 v[20:35], a[56:59], a[248:251], v[20:35]
    ds_read_b128 a[216:219], v218 offset:41984
    v_exp_f32 v65, v65
    v_add_f32 v254, v68, v69
    v_add_f32 v252, v52, v53
    v_add_f32 v254, v254, v70
    v_add_f32 v252, v252, v54
    v_mfma_f32_32x32x16_bf16 v[20:35], a[60:63], a[252:255], v[20:35]
    ds_read_b128 a[220:223], v218 offset:46080
    v_add_f32 v254, v254, v71
    v_add_f32 v252, v252, v55
    v_add_f32 v254, v254, v72
    v_add_f32 v252, v252, v56
    v_add_f32 v254, v254, v73
    v_add_f32 v252, v252, v57
    s_waitcnt lgkmcnt(4)
    v_mfma_f32_32x32x16_bf16 v[20:35], a[64:67], a[192:195], v[20:35]
    ds_read_b128 a[224:227], v218 offset:34816
    v_add_f32 v254, v254, v74
    v_add_f32 v252, v252, v58
    v_add_f32 v254, v254, v75
    v_add_f32 v252, v252, v59
    v_add_f32 v254, v254, v76
    v_add_f32 v252, v252, v60
    v_mfma_f32_32x32x16_bf16 v[20:35], a[68:71], a[196:199], v[20:35]
    ds_read_b128 a[228:231], v218 offset:38912
    v_add_f32 v254, v254, v77
    v_add_f32 v252, v252, v61
    v_add_f32 v254, v254, v78
    v_add_f32 v252, v252, v62
    v_add_f32 v254, v254, v79
    v_add_f32 v252, v252, v63
    v_mfma_f32_32x32x16_bf16 v[20:35], a[72:75], a[200:203], v[20:35]
    ds_read_b128 a[232:235], v218 offset:43008
    v_add_f32 v254, v254, v80
    v_add_f32 v252, v252, v64
    v_add_f32 v254, v254, v81
    v_add_f32 v252, v252, v65
    s_nop 1
    v_permlane32_swap_b32 v254, v252
    v_add_f32 v254, v254, v252
    v_mfma_f32_32x32x16_bf16 v[20:35], a[76:79], a[204:207], v[20:35]
    ds_read_b128 a[236:239], v218 offset:47104
    v_rcp_f32 v254, v254
    s_nop 0
    v_mov_b32 v252, v254
    s_nop 1
    v_permlane32_swap_b32 v254, v252
    v_mul_f32 v68, v68, v254
    v_cvt_pk_bf16_f32 v4, 0, v68
    s_waitcnt lgkmcnt(4)
    v_mfma_f32_32x32x16_bf16 v[20:35], a[80:83], a[208:211], v[20:35]
    v_mul_f32 v69, v69, v254
    v_mul_f32 v70, v70, v254
    v_cvt_pk_bf16_f32 v5, v69, v70
    v_mul_f32 v71, v71, v254
    v_mul_f32 v72, v72, v254
    v_cvt_pk_bf16_f32 v6, v71, v72
    v_mfma_f32_32x32x16_bf16 v[20:35], a[84:87], a[212:215], v[20:35]
    v_mul_f32 v73, v73, v254
    v_mul_f32 v74, v74, v254
    v_cvt_pk_bf16_f32 v7, v73, v74
    v_mul_f32 v75, v75, v254
    v_cvt_pk_bf16_f32 v8, 0, v75
    v_mul_f32 v76, v76, v254
    v_mfma_f32_32x32x16_bf16 v[20:35], a[88:91], a[216:219], v[20:35]
    v_mul_f32 v77, v77, v254
    v_cvt_pk_bf16_f32 v9, v76, v77
    v_mul_f32 v78, v78, v254
    v_mul_f32 v79, v79, v254
    v_cvt_pk_bf16_f32 v10, v78, v79
    v_mul_f32 v80, v80, v254
    v_mfma_f32_32x32x16_bf16 v[20:35], a[92:95], a[220:223], v[20:35]
    v_mul_f32 v81, v81, v254
    v_cvt_pk_bf16_f32 v11, v80, v81
    v_mul_f32 v52, v52, v252
    v_cvt_pk_bf16_f32 v12, 0, v52
    v_mul_f32 v53, v53, v252
    v_mul_f32 v54, v54, v252
    s_waitcnt lgkmcnt(0)
    v_mfma_f32_32x32x16_bf16 v[20:35], a[96:99], a[224:227], v[20:35]
    v_cvt_pk_bf16_f32 v13, v53, v54
    v_mul_f32 v55, v55, v252
    v_mul_f32 v56, v56, v252
    v_cvt_pk_bf16_f32 v14, v55, v56
    v_mul_f32 v57, v57, v252
    v_mul_f32 v58, v58, v252
    v_mfma_f32_32x32x16_bf16 v[20:35], a[100:103], a[228:231], v[20:35]
    v_cvt_pk_bf16_f32 v15, v57, v58
    v_mul_f32 v59, v59, v252
    v_cvt_pk_bf16_f32 v16, 0, v59
    v_mul_f32 v60, v60, v252
    v_mul_f32 v61, v61, v252
    v_cvt_pk_bf16_f32 v17, v60, v61
    v_mul_f32 v62, v62, v252
    v_mul_f32 v63, v63, v252
    v_cvt_pk_bf16_f32 v18, v62, v63
    v_mul_f32 v64, v64, v252
    v_mul_f32 v65, v65, v252
    v_cvt_pk_bf16_f32 v19, v64, v65
    ds_write_b128 v240, v[4:7]
    ds_write_b128 v241, v[8:11]
    ds_write_b128 v242, v[12:15]
    ds_write_b128 v243, v[16:19]
    s_waitcnt lgkmcnt(0)
    s_barrier
    ds_read_b64_tr_b16 a[176:177], v190 offset:0
    ds_read_b64_tr_b16 a[178:179], v190 offset:1024
    ds_read_b64_tr_b16 a[180:181], v190 offset:4096
    ds_read_b64_tr_b16 a[182:183], v190 offset:5120
    ds_read_b64_tr_b16 a[184:185], v190 offset:8192
    ds_read_b64_tr_b16 a[186:187], v190 offset:9216
    ds_read_b64_tr_b16 a[188:189], v190 offset:12288
    ds_read_b64_tr_b16 a[190:191], v190 offset:13312
    v_mfma_f32_32x32x16_bf16 v[20:35], a[104:107], a[232:235], v[20:35]
    v_mfma_f32_32x32x16_bf16 v[20:35], a[108:111], a[236:239], v[20:35]
    v_cvt_pk_bf16_f32 v52, v36, v37
    v_cvt_pk_bf16_f32 v53, v38, v39
    v_cvt_pk_bf16_f32 v54, v40, v41
    v_cvt_pk_bf16_f32 v55, v42, v43
    v_cvt_pk_bf16_f32 v56, v44, v45
    v_cvt_pk_bf16_f32 v57, v46, v47
    v_cvt_pk_bf16_f32 v58, v48, v49
    v_cvt_pk_bf16_f32 v59, v50, v51
    s_mov_b32 exec_lo, 0xfcffffff
    s_mov_b32 exec_hi, 0xfcffffff
    s_nop 1
    v_cvt_pk_bf16_f32 v4, v20, v21
    v_cvt_pk_bf16_f32 v5, v22, v23
    v_cvt_pk_bf16_f32 v6, v24, v25
    v_cvt_pk_bf16_f32 v7, v26, v27
    ds_write_b128 v191, v[4:7]
    v_cvt_pk_bf16_f32 v8, v28, v29
    v_cvt_pk_bf16_f32 v9, v30, v31
    v_cvt_pk_bf16_f32 v10, v32, v33
    v_cvt_pk_bf16_f32 v11, v34, v35
    ds_write_b128 v191, v[8:11] offset:32768
    s_mov_b64 exec, -1
    s_add_u32 m0, s57, 0x26000
    s_mov_b32 s38, 351232
    buffer_load_dwordx4 v182, s[16:19], s38 offen lds
    s_add_u32 m0, s57, 0x27000
    s_mov_b32 s38, 376320
    buffer_load_dwordx4 v182, s[16:19], s38 offen lds
    s_waitcnt vmcnt(7)
    s_waitcnt lgkmcnt(0)
    s_barrier
    ds_read_b128 a[144:147], v189 offset:0
    ds_read_b128 a[148:151], v189 offset:256
    ds_read_b128 a[152:155], v189 offset:4096
    ds_read_b128 a[156:159], v189 offset:4352
    ds_read_b128 a[160:163], v189 offset:8192
    ds_read_b128 a[164:167], v189 offset:8448
    ds_read_b128 a[168:171], v189 offset:12288
    ds_read_b128 a[172:175], v189 offset:12544
    v_mfma_f32_32x32x16_bf16 v[4:19], v[52:55], v[92:95], 0
    s_mov_b32 exec_lo, 0x80000000
    s_mov_b32 exec_hi, 0x80000000
    ds_write_b128 v188, v[36:39] offset:0
    ds_write_b128 v188, v[40:43] offset:32
    ds_write_b128 v188, v[44:47] offset:64
    ds_write_b128 v188, v[48:51] offset:96
    s_mov_b64 exec, -1
    v_mfma_f32_32x32x16_bf16 v[4:19], v[56:59], v[96:99], v[4:19]
    ds_read_b32 v251, v187
    s_waitcnt lgkmcnt(9)
    v_mfma_f32_16x16x32_bf16 v[20:23], a[176:179], a[144:147], 0
    ds_read_b128 a[192:195], v193 offset:16384
    v_mfma_f32_16x16x32_bf16 v[24:27], a[176:179], a[148:151], 0
    ds_read_b128 a[196:199], v193 offset:20480
    v_mfma_f32_16x16x32_bf16 v[20:23], a[180:183], a[152:155], v[20:23]
    ds_read_b128 a[200:203], v193 offset:24576
    v_mfma_f32_16x16x32_bf16 v[24:27], a[180:183], a[156:159], v[24:27]
    ds_read_b128 a[204:207], v193 offset:28672
    s_waitcnt lgkmcnt(9)
    v_mfma_f32_16x16x32_bf16 v[20:23], a[184:187], a[160:163], v[20:23]
    ds_read_b128 a[208:211], v193 offset:17408
    v_mfma_f32_16x16x32_bf16 v[24:27], a[184:187], a[164:167], v[24:27]
    ds_read_b128 a[212:215], v193 offset:21504
    v_mfma_f32_16x16x32_bf16 v[20:23], a[188:191], a[168:171], v[20:23]
    ds_read_b128 a[216:219], v193 offset:25600
    v_mfma_f32_16x16x32_bf16 v[24:27], a[188:191], a[172:175], v[24:27]
    ds_read_b128 a[220:223], v193 offset:29696
    v_mfma_f32_32x32x16_bf16 v[36:51], v[52:55], v[84:87], 0
    s_mov_b32 s38, 0xffff0000
    s_waitcnt lgkmcnt(8)
    v_mul_f32 v250, 0xbfb8aa3b, v251
    v_exp_f32 v250, v250
    v_add_u32 v249, 0x8000, v185
    v_cvt_pk_bf16_f32 v252, v20, v21
    v_cvt_pk_bf16_f32 v253, v22, v23
    v_cvt_pk_bf16_f32 v254, v24, v25
    v_cvt_pk_bf16_f32 v255, v26, v27
    v_add_f32 v250, 1.0, v250
    v_permlane16_swap_b32 v252, v254
    v_permlane16_swap_b32 v253, v255
    v_rcp_f32 v250, v250
    v_and_or_b32 v252, v252, s38, v199
    buffer_store_dwordx4 v[252:255], v218, s[28:31], s12 offen sc1
    v_mfma_f32_32x32x16_bf16 v[36:51], v[56:59], v[88:91], v[36:51]
    s_waitcnt lgkmcnt(4)
    v_mfma_f32_32x32x16_bf16 v[68:83], a[192:195], a[0:3], 0
    ds_read_b128 a[224:227], v193 offset:18432
    s_add_u32 m0, s57, 0x18000
    s_mov_b32 s38, 0
    buffer_load_dwordx4 v182, s[16:19], s38 offen lds
    s_add_u32 s39, s64, 1
    s_and_b32 s39, s39, 3
    s_lshl_b32 s39, s39, 12
    s_add_u32 s51, s39, s13
    v_mfma_f32_32x32x16_bf16 v[68:83], a[196:199], a[4:7], v[68:83]
    ds_read_b128 a[228:231], v193 offset:22528
    s_add_u32 s39, s64, 2
    s_and_b32 s39, s39, 3
    s_lshl_b32 s39, s39, 12
    s_add_u32 s52, s39, s13
    s_add_u32 s39, s64, 3
    s_and_b32 s39, s39, 3
    s_lshl_b32 s39, s39, 12
    s_add_u32 s53, s39, s13
    v_mfma_f32_32x32x16_bf16 v[68:83], a[200:203], a[8:11], v[68:83]
    ds_read_b128 a[232:235], v193 offset:26624
    s_add_u32 m0, s57, 0x1f000
    s_mov_b32 s38, 175616
    buffer_load_dwordx4 v182, s[16:19], s38 offen lds
    s_add_u32 s39, s64, 4
    s_and_b32 s39, s39, 3
    s_lshl_b32 s39, s39, 12
    s_add_u32 s54, s39, s13
    v_mfma_f32_32x32x16_bf16 v[68:83], a[204:207], a[12:15], v[68:83]
    ds_read_b128 a[236:239], v193 offset:30720
    v_sub_f32 v223, v36, v12
    v_add_f32 v222, v44, v4
    v_cvt_pk_bf16_f32 v116, v223, v222
    v_sub_f32 v223, v37, v13
    v_add_f32 v222, v45, v5
    v_cvt_pk_bf16_f32 v117, v223, v222
    v_sub_f32 v223, v38, v14
    s_waitcnt lgkmcnt(4)
    v_mfma_f32_32x32x16_bf16 v[68:83], a[208:211], a[16:19], v[68:83]
    ds_read_b128 a[240:243], v193 offset:19456
    s_add_u32 m0, s57, 0x19000
    s_mov_b32 s38, 25088
    buffer_load_dwordx4 v182, s[16:19], s38 offen lds
    v_add_f32 v222, v46, v6
    v_cvt_pk_bf16_f32 v118, v223, v222
    v_sub_f32 v223, v39, v15
    v_add_f32 v222, v47, v7
    v_mfma_f32_32x32x16_bf16 v[68:83], a[212:215], a[20:23], v[68:83]
    ds_read_b128 a[244:247], v193 offset:23552
    v_cvt_pk_bf16_f32 v119, v223, v222
    ds_write_b128 v230, v[116:119]
    v_sub_f32 v223, v40, v16
    v_add_f32 v222, v48, v8
    v_cvt_pk_bf16_f32 v120, v223, v222
    v_sub_f32 v223, v41, v17
    v_add_f32 v222, v49, v9
    v_cvt_pk_bf16_f32 v121, v223, v222
    v_sub_f32 v223, v42, v18
    v_add_f32 v222, v50, v10
    v_cvt_pk_bf16_f32 v122, v223, v222
    v_sub_f32 v223, v43, v19
    v_add_f32 v222, v51, v11
    v_cvt_pk_bf16_f32 v123, v223, v222
    ds_write_b128 v231, v[120:123]
    s_waitcnt lgkmcnt(0)
    s_barrier
    ds_read2st64_b32 v[116:117], v228 offset0:0 offset1:16
    ds_read2st64_b32 v[118:119], v228 offset0:32 offset1:48
    ds_read2st64_b32 v[120:121], v229 offset0:0 offset1:16
    ds_read2st64_b32 v[122:123], v229 offset0:32 offset1:48
    s_add_u32 s39, s14, 0x40000
    s_lshl_b32 s47, s58, 7
    v_mfma_f32_32x32x16_bf16 v[68:83], a[216:219], a[24:27], v[68:83]
    ds_read_b128 a[248:251], v193 offset:27648
    s_add_u32 m0, s57, 0x20000
    s_mov_b32 s38, 200704
    buffer_load_dwordx4 v182, s[16:19], s38 offen lds
    s_add_u32 s47, s47, 0x20000
    v_lshlrev_b32 v223, 2, v216
    v_sub_f32 v221, 1.0, v250
    v_mfma_f32_32x32x16_bf16 v[68:83], a[220:223], a[28:31], v[68:83]
    ds_read_b128 a[252:255], v193 offset:31744
    s_cmp_eq_u32 s34, 0
    s_cselect_b32 exec_lo, -1, 0
    s_mov_b32 exec_hi, 0
    buffer_store_dword v250, v223, s[28:31], s47 offen sc1
    s_mov_b64 exec, -1
    v_mfma_f32_32x32x16_bf16 v[68:83], a[224:227], a[32:35], v[68:83]
    ds_read_b128 a[192:195], v193 offset:32768
    s_add_u32 m0, s57, 0x1a000
    s_mov_b32 s38, 50176
    buffer_load_dwordx4 v182, s[16:19], s38 offen lds
    s_waitcnt lgkmcnt(5)
    buffer_store_dwordx4 v[116:119], v186, s[28:31], s14 offen sc1
    s_waitcnt lgkmcnt(3)
    buffer_store_dwordx4 v[120:123], v186, s[28:31], s39 offen sc1
    v_mfma_f32_32x32x16_bf16 v[68:83], a[228:231], a[36:39], v[68:83]
    ds_read_b128 a[196:199], v193 offset:36864
    v_mfma_f32_32x32x16_bf16 v[68:83], a[232:235], a[40:43], v[68:83]
    ds_read_b128 a[200:203], v193 offset:40960
    s_add_u32 m0, s57, 0x21000
    s_mov_b32 s38, 225792
    buffer_load_dwordx4 v182, s[16:19], s38 offen lds
    v_mfma_f32_32x32x16_bf16 v[68:83], a[236:239], a[44:47], v[68:83]
    ds_read_b128 a[204:207], v193 offset:45056
    s_waitcnt lgkmcnt(4)
    v_mfma_f32_32x32x16_bf16 v[68:83], a[240:243], a[48:51], v[68:83]
    ds_read_b128 a[208:211], v193 offset:33792
    s_add_u32 m0, s57, 0x1b000
    s_mov_b32 s38, 75264
    buffer_load_dwordx4 v182, s[16:19], s38 offen lds
    v_mfma_f32_32x32x16_bf16 v[68:83], a[244:247], a[52:55], v[68:83]
    ds_read_b128 a[212:215], v193 offset:37888
    v_mfma_f32_32x32x16_bf16 v[68:83], a[248:251], a[56:59], v[68:83]
    ds_read_b128 a[216:219], v193 offset:41984
    s_add_u32 m0, s57, 0x22000
    s_mov_b32 s38, 250880
    buffer_load_dwordx4 v182, s[16:19], s38 offen lds
    v_mfma_f32_32x32x16_bf16 v[68:83], a[252:255], a[60:63], v[68:83]
    ds_read_b128 a[220:223], v193 offset:46080
    s_waitcnt lgkmcnt(4)
    v_mfma_f32_32x32x16_bf16 v[68:83], a[192:195], a[64:67], v[68:83]
    ds_read_b128 a[224:227], v193 offset:34816
    s_add_u32 m0, s57, 0x1c000
    s_mov_b32 s38, 100352
    buffer_load_dwordx4 v182, s[16:19], s38 offen lds
    v_mfma_f32_32x32x16_bf16 v[68:83], a[196:199], a[68:71], v[68:83]
    ds_read_b128 a[228:231], v193 offset:38912
    v_mfma_f32_32x32x16_bf16 v[68:83], a[200:203], a[72:75], v[68:83]
    ds_read_b128 a[232:235], v193 offset:43008
    s_add_u32 m0, s57, 0x23000
    s_mov_b32 s38, 275968
    buffer_load_dwordx4 v182, s[16:19], s38 offen lds
    v_mfma_f32_32x32x16_bf16 v[68:83], a[204:207], a[76:79], v[68:83]
    ds_read_b128 a[236:239], v193 offset:47104
    s_waitcnt lgkmcnt(4)
    v_mfma_f32_32x32x16_bf16 v[68:83], a[208:211], a[80:83], v[68:83]
    s_add_u32 m0, s57, 0x1d000
    s_mov_b32 s38, 125440
    buffer_load_dwordx4 v182, s[16:19], s38 offen lds
    v_mfma_f32_32x32x16_bf16 v[68:83], a[212:215], a[84:87], v[68:83]
    v_mfma_f32_32x32x16_bf16 v[68:83], a[216:219], a[88:91], v[68:83]
    s_add_u32 m0, s57, 0x24000
    s_mov_b32 s38, 301056
    buffer_load_dwordx4 v182, s[16:19], s38 offen lds
    v_mfma_f32_32x32x16_bf16 v[68:83], a[220:223], a[92:95], v[68:83]
    s_waitcnt lgkmcnt(0)
    v_mfma_f32_32x32x16_bf16 v[68:83], a[224:227], a[96:99], v[68:83]
    s_add_u32 m0, s57, 0x1e000
    s_mov_b32 s38, 150528
    buffer_load_dwordx4 v182, s[16:19], s38 offen lds
    v_mfma_f32_32x32x16_bf16 v[68:83], a[228:231], a[100:103], v[68:83]
    v_mfma_f32_32x32x16_bf16 v[68:83], a[232:235], a[104:107], v[68:83]
    s_add_u32 m0, s57, 0x25000
    s_mov_b32 s38, 326144
    buffer_load_dwordx4 v182, s[16:19], s38 offen lds
    v_mfma_f32_32x32x16_bf16 v[68:83], a[236:239], a[108:111], v[68:83]
    s_waitcnt vmcnt(9)
    s_mov_b32 exec_lo, 0x1
    s_mov_b32 exec_hi, 0x0
    buffer_store_dword v197, v196, s[28:31], s15 offen sc1
    s_mov_b64 exec, -1
    s_nop 6
    v_cvt_pk_bf16_f32 v108, v68, v69
    v_cvt_pk_bf16_f32 v109, v70, v71
    v_cvt_pk_bf16_f32 v110, v72, v73
    v_cvt_pk_bf16_f32 v111, v74, v75
    s_nop 1
    v_mfma_f32_32x32x16_bf16 v[84:99], v[100:103], v[108:111], 0
    v_cvt_pk_bf16_f32 v112, v76, v77
    v_cvt_pk_bf16_f32 v113, v78, v79
    v_cvt_pk_bf16_f32 v114, v80, v81
    v_cvt_pk_bf16_f32 v115, v82, v83
    s_nop 1
    v_mfma_f32_32x32x16_bf16 v[84:99], v[104:107], v[112:115], v[84:99]
    s_nop 11
    v_max3_f32 v254, v84, v85, v86
    v_min3_f32 v252, v84, v85, v86
    v_max3_f32 v254, v254, v87, v88
    v_min3_f32 v252, v252, v87, v88
    v_max3_f32 v254, v254, v89, v90
    v_min3_f32 v252, v252, v89, v90
    v_max3_f32 v254, v254, v91, v92
    v_min3_f32 v252, v252, v91, v92
    v_max3_f32 v254, v254, v93, v94
    v_min3_f32 v252, v252, v93, v94
    v_max3_f32 v254, v254, v95, v96
    buffer_load_dwordx4 v[4:7], v185, s[28:31], s51 offen offset:0 sc1
    v_min3_f32 v252, v252, v95, v96
    v_max_f32 v254, v254, v97
    v_max_f32_e64 v252, -v252, -v97
    s_nop 1
    v_permlane32_swap_b32 v254, v252
    v_max_f32 v254, v254, v252
    buffer_load_dwordx4 v[8:11], v185, s[28:31], s51 offen offset:256 sc1
    v_mul_f32 v254, 0xbfb8aa3b, v254
    v_mov_b32 v252, v254
    s_nop 1
    v_permlane32_swap_b32 v254, v252
    v_pk_fma_f32 v[100:101], v[84:85], s[66:67], v[254:255] op_sel_hi:[1,0,0]
    v_pk_fma_f32 v[84:85], v[84:85], s[66:67], v[252:253] op_sel_hi:[1,0,0] neg_lo:[1,0,0] neg_hi:[1,0,0]
    buffer_load_dwordx4 v[12:15], v249, s[28:31], s51 offen offset:0 sc1
    v_pk_fma_f32 v[102:103], v[86:87], s[66:67], v[254:255] op_sel_hi:[1,0,0]
    v_pk_fma_f32 v[86:87], v[86:87], s[66:67], v[252:253] op_sel_hi:[1,0,0] neg_lo:[1,0,0] neg_hi:[1,0,0]
    v_pk_fma_f32 v[104:105], v[88:89], s[66:67], v[254:255] op_sel_hi:[1,0,0]
    v_pk_fma_f32 v[88:89], v[88:89], s[66:67], v[252:253] op_sel_hi:[1,0,0] neg_lo:[1,0,0] neg_hi:[1,0,0]
    v_pk_fma_f32 v[106:107], v[90:91], s[66:67], v[254:255] op_sel_hi:[1,0,0]
    buffer_load_dwordx4 v[16:19], v249, s[28:31], s51 offen offset:256 sc1
    v_pk_fma_f32 v[90:91], v[90:91], s[66:67], v[252:253] op_sel_hi:[1,0,0] neg_lo:[1,0,0] neg_hi:[1,0,0]
    v_pk_fma_f32 v[108:109], v[92:93], s[66:67], v[254:255] op_sel_hi:[1,0,0]
    v_pk_fma_f32 v[92:93], v[92:93], s[66:67], v[252:253] op_sel_hi:[1,0,0] neg_lo:[1,0,0] neg_hi:[1,0,0]
    v_pk_fma_f32 v[110:111], v[94:95], s[66:67], v[254:255] op_sel_hi:[1,0,0]
    v_pk_fma_f32 v[94:95], v[94:95], s[66:67], v[252:253] op_sel_hi:[1,0,0] neg_lo:[1,0,0] neg_hi:[1,0,0]
    buffer_load_dwordx4 v[20:23], v185, s[28:31], s52 offen offset:0 sc1
    v_pk_fma_f32 v[112:113], v[96:97], s[66:67], v[254:255] op_sel_hi:[1,0,0]
    v_pk_fma_f32 v[96:97], v[96:97], s[66:67], v[252:253] op_sel_hi:[1,0,0] neg_lo:[1,0,0] neg_hi:[1,0,0]
    v_exp_f32 v100, v100
    v_exp_f32 v84, v84
    v_exp_f32 v101, v101
    buffer_load_dwordx4 v[24:27], v185, s[28:31], s52 offen offset:256 sc1
    v_exp_f32 v85, v85
    v_exp_f32 v102, v102
    v_exp_f32 v86, v86
    v_exp_f32 v103, v103
    v_exp_f32 v87, v87
    buffer_load_dwordx4 v[28:31], v249, s[28:31], s52 offen offset:0 sc1
    v_exp_f32 v104, v104
    v_exp_f32 v88, v88
    v_exp_f32 v105, v105
    v_exp_f32 v89, v89
    v_exp_f32 v106, v106
    buffer_load_dwordx4 v[32:35], v249, s[28:31], s52 offen offset:256 sc1
    v_exp_f32 v90, v90
    v_exp_f32 v107, v107
    v_exp_f32 v91, v91
    v_exp_f32 v108, v108
    v_exp_f32 v92, v92
    buffer_load_dwordx4 v[36:39], v185, s[28:31], s53 offen offset:0 sc1
    v_exp_f32 v109, v109
    v_exp_f32 v93, v93
    v_exp_f32 v110, v110
    v_exp_f32 v94, v94
    v_exp_f32 v111, v111
    buffer_load_dwordx4 v[40:43], v185, s[28:31], s53 offen offset:256 sc1
    v_exp_f32 v95, v95
    v_exp_f32 v112, v112
    v_exp_f32 v96, v96
    v_exp_f32 v113, v113
    v_exp_f32 v97, v97
    buffer_load_dwordx4 v[44:47], v249, s[28:31], s53 offen offset:0 sc1
    v_pk_add_f32 v[254:255], v[100:101], v[102:103]
    v_pk_add_f32 v[252:253], v[84:85], v[86:87]
    v_pk_add_f32 v[254:255], v[254:255], v[104:105]
    v_pk_add_f32 v[252:253], v[252:253], v[88:89]
    v_pk_add_f32 v[254:255], v[254:255], v[106:107]
    buffer_load_dwordx4 v[48:51], v249, s[28:31], s53 offen offset:256 sc1
    v_pk_add_f32 v[252:253], v[252:253], v[90:91]
    v_pk_add_f32 v[254:255], v[254:255], v[108:109]
    v_pk_add_f32 v[252:253], v[252:253], v[92:93]
    v_pk_add_f32 v[254:255], v[254:255], v[110:111]
    v_pk_add_f32 v[252:253], v[252:253], v[94:95]
    s_waitcnt vmcnt(13)
    s_barrier
    buffer_load_dwordx4 v[52:55], v185, s[28:31], s54 offen offset:0 sc1
    v_pk_add_f32 v[254:255], v[254:255], v[112:113]
    v_pk_add_f32 v[252:253], v[252:253], v[96:97]
    ds_read_b64_tr_b16 a[128:129], v232 offset:0
    ds_read_b64_tr_b16 a[130:131], v232 offset:512
    v_add_f32 v254, v254, v255
    v_add_f32 v252, v252, v253
    ds_read_b64_tr_b16 a[132:133], v233 offset:0
    ds_read_b64_tr_b16 a[134:135], v233 offset:512
    v_permlane32_swap_b32 v254, v252
    buffer_load_dwordx4 v[56:59], v185, s[28:31], s54 offen offset:256 sc1
    v_add_f32 v254, v254, v252
    ds_read_b64_tr_b16 a[136:137], v234 offset:0
    ds_read_b64_tr_b16 a[138:139], v234 offset:512
    v_rcp_f32 v254, v254
    s_nop 0
    v_mov_b32 v252, v254
    ds_read_b64_tr_b16 a[140:141], v235 offset:0
    ds_read_b64_tr_b16 a[142:143], v235 offset:512
    v_permlane32_swap_b32 v254, v252
    v_pk_mul_f32 v[100:101], v[100:101], v[254:255] op_sel_hi:[1,0]
    buffer_load_dwordx4 v[60:63], v249, s[28:31], s54 offen offset:0 sc1
    v_pk_mul_f32 v[102:103], v[102:103], v[254:255] op_sel_hi:[1,0]
    v_pk_mul_f32 v[104:105], v[104:105], v[254:255] op_sel_hi:[1,0]
    ds_read_b64_tr_b16 a[144:145], v232 offset:4096
    ds_read_b64_tr_b16 a[146:147], v232 offset:4608
    v_pk_mul_f32 v[106:107], v[106:107], v[254:255] op_sel_hi:[1,0]
    v_pk_mul_f32 v[108:109], v[108:109], v[254:255] op_sel_hi:[1,0]
    ds_read_b64_tr_b16 a[148:149], v233 offset:4096
    ds_read_b64_tr_b16 a[150:151], v233 offset:4608
    v_pk_mul_f32 v[110:111], v[110:111], v[254:255] op_sel_hi:[1,0]
    buffer_load_dwordx4 v[64:67], v249, s[28:31], s54 offen offset:256 sc1
    v_pk_mul_f32 v[112:113], v[112:113], v[254:255] op_sel_hi:[1,0]
    ds_read_b64_tr_b16 a[152:153], v234 offset:4096
    ds_read_b64_tr_b16 a[154:155], v234 offset:4608
    v_cvt_pk_bf16_f32 v68, 0, v100
    v_cvt_pk_bf16_f32 v69, v101, v102
    ds_read_b64_tr_b16 a[156:157], v235 offset:4096
    ds_read_b64_tr_b16 a[158:159], v235 offset:4608
    v_cvt_pk_bf16_f32 v70, v103, v104
    v_cvt_pk_bf16_f32 v71, v105, v106
    ds_read_b64_tr_b16 a[160:161], v232 offset:12288
    ds_read_b64_tr_b16 a[162:163], v232 offset:12800
    v_cvt_pk_bf16_f32 v72, 0, v107
    v_cvt_pk_bf16_f32 v73, v108, v109
    ds_read_b64_tr_b16 a[164:165], v233 offset:12288
    ds_read_b64_tr_b16 a[166:167], v233 offset:12800
    v_cvt_pk_bf16_f32 v74, v110, v111
    v_cvt_pk_bf16_f32 v75, v112, v113
    ds_read_b64_tr_b16 a[168:169], v234 offset:12288
    ds_read_b64_tr_b16 a[170:171], v234 offset:12800
    v_pk_mul_f32 v[84:85], v[84:85], v[252:253] op_sel_hi:[1,0]
    v_pk_mul_f32 v[86:87], v[86:87], v[252:253] op_sel_hi:[1,0]
    ds_read_b64_tr_b16 a[172:173], v235 offset:12288
    ds_read_b64_tr_b16 a[174:175], v235 offset:12800
    v_pk_mul_f32 v[88:89], v[88:89], v[252:253] op_sel_hi:[1,0]
    v_pk_mul_f32 v[90:91], v[90:91], v[252:253] op_sel_hi:[1,0]
    ds_read_b64_tr_b16 a[176:177], v232 offset:20480
    ds_read_b64_tr_b16 a[178:179], v232 offset:20992
    v_pk_mul_f32 v[92:93], v[92:93], v[252:253] op_sel_hi:[1,0]
    v_pk_mul_f32 v[94:95], v[94:95], v[252:253] op_sel_hi:[1,0]
    ds_read_b64_tr_b16 a[180:181], v233 offset:20480
    ds_read_b64_tr_b16 a[182:183], v233 offset:20992
    v_pk_mul_f32 v[96:97], v[96:97], v[252:253] op_sel_hi:[1,0]
    v_cvt_pk_bf16_f32 v76, 0, v84
    ds_read_b64_tr_b16 a[184:185], v234 offset:20480
    ds_read_b64_tr_b16 a[186:187], v234 offset:20992
    v_cvt_pk_bf16_f32 v77, v85, v86
    v_cvt_pk_bf16_f32 v78, v87, v88
    ds_read_b64_tr_b16 a[188:189], v235 offset:20480
    ds_read_b64_tr_b16 a[190:191], v235 offset:20992
    v_cvt_pk_bf16_f32 v79, v89, v90
    v_cvt_pk_bf16_f32 v80, 0, v91
    v_cvt_pk_bf16_f32 v81, v92, v93
    v_cvt_pk_bf16_f32 v82, v94, v95
    v_cvt_pk_bf16_f32 v83, v96, v97
    v_mov_b32 v116, 0
    v_mov_b32 v117, 0
    v_mov_b32 v118, 0
    v_mov_b32 v119, 0
    v_mov_b32 v120, 0
    v_mov_b32 v121, 0
    v_mov_b32 v122, 0
    v_mov_b32 v123, 0
    s_mov_b32 s65, 0x8000
    s_mov_b32 s3, 0
    s_waitcnt vmcnt(12)
    v_cmp_ne_u16_e64 s[40:41], s61, v4
    v_cmp_ne_u16_e64 s[42:43], s61, v8
    v_cmp_ne_u16_e64 s[44:45], s61, v12
    v_cmp_ne_u16_e64 s[46:47], s61, v16
    s_or_b64 s[40:41], s[40:41], s[42:43]
    s_or_b64 s[44:45], s[44:45], s[46:47]
    s_or_b64 s[40:41], s[40:41], s[44:45]
    s_cbranch_scc1 .La_miss0
    v_mfma_f32_16x16x32_bf16 v[116:119], v[236:239], v[4:7], v[116:119]
    v_mfma_f32_16x16x32_bf16 v[120:123], v[236:239], v[8:11], v[120:123]
    v_mfma_f32_16x16x32_bf16 v[116:119], v[236:239], v[12:15], v[116:119]
    v_mfma_f32_16x16x32_bf16 v[120:123], v[236:239], v[16:19], v[120:123]
.La_next0:
    s_waitcnt vmcnt(8)
    v_cmp_ne_u16_e64 s[40:41], s61, v20
    v_cmp_ne_u16_e64 s[42:43], s61, v24
    v_cmp_ne_u16_e64 s[44:45], s61, v28
    v_cmp_ne_u16_e64 s[46:47], s61, v32
    s_or_b64 s[40:41], s[40:41], s[42:43]
    s_or_b64 s[44:45], s[44:45], s[46:47]
    s_or_b64 s[40:41], s[40:41], s[44:45]
    s_cbranch_scc1 .La_miss1
    v_mfma_f32_16x16x32_bf16 v[116:119], v[236:239], v[20:23], v[116:119]
    v_mfma_f32_16x16x32_bf16 v[120:123], v[236:239], v[24:27], v[120:123]
    v_mfma_f32_16x16x32_bf16 v[116:119], v[236:239], v[28:31], v[116:119]
    v_mfma_f32_16x16x32_bf16 v[120:123], v[236:239], v[32:35], v[120:123]
.La_next1:
    s_waitcnt vmcnt(4)
    v_cmp_ne_u16_e64 s[40:41], s61, v36
    v_cmp_ne_u16_e64 s[42:43], s61, v40
    v_cmp_ne_u16_e64 s[44:45], s61, v44
    v_cmp_ne_u16_e64 s[46:47], s61, v48
    s_or_b64 s[40:41], s[40:41], s[42:43]
    s_or_b64 s[44:45], s[44:45], s[46:47]
    s_or_b64 s[40:41], s[40:41], s[44:45]
    s_cbranch_scc1 .La_miss2
    v_mfma_f32_16x16x32_bf16 v[116:119], v[236:239], v[36:39], v[116:119]
    v_mfma_f32_16x16x32_bf16 v[120:123], v[236:239], v[40:43], v[120:123]
    v_mfma_f32_16x16x32_bf16 v[116:119], v[236:239], v[44:47], v[116:119]
    v_mfma_f32_16x16x32_bf16 v[120:123], v[236:239], v[48:51], v[120:123]
.La_next2:
    s_waitcnt vmcnt(0)
    v_cmp_ne_u16_e64 s[40:41], s61, v52
    v_cmp_ne_u16_e64 s[42:43], s61, v56
    v_cmp_ne_u16_e64 s[44:45], s61, v60
    v_cmp_ne_u16_e64 s[46:47], s61, v64
    s_or_b64 s[40:41], s[40:41], s[42:43]
    s_or_b64 s[44:45], s[44:45], s[46:47]
    s_or_b64 s[40:41], s[40:41], s[44:45]
    s_cbranch_scc1 .La_miss3
    v_mfma_f32_16x16x32_bf16 v[116:119], v[236:239], v[52:55], v[116:119]
    v_mfma_f32_16x16x32_bf16 v[120:123], v[236:239], v[56:59], v[120:123]
    v_mfma_f32_16x16x32_bf16 v[116:119], v[236:239], v[60:63], v[116:119]
    v_mfma_f32_16x16x32_bf16 v[120:123], v[236:239], v[64:67], v[120:123]
.La_next3:
    s_cmp_lg_u32 s3, 0
    s_cbranch_scc1 .La_late
.La_done:
    buffer_load_dword v251, v181, s[28:31], 0 offen sc1
    s_nop 3
    v_cvt_pk_bf16_f32 v84, v116, v117
    v_cvt_pk_bf16_f32 v85, v118, v119
    ds_write_b64 v184, v[84:85] offset:0
    v_cvt_pk_bf16_f32 v86, v120, v121
    v_cvt_pk_bf16_f32 v87, v122, v123
    ds_write_b64 v184, v[86:87] offset:256
    s_waitcnt lgkmcnt(0)
    s_barrier
    ds_read_b128 v[84:87], v218 offset:3072
    ds_read_b128 v[88:91], v218 offset:7168
    ds_read_b128 v[92:95], v218 offset:11264
    ds_read_b128 v[96:99], v218 offset:15360
    s_add_u32 s51, s23, 4096
    s_add_u32 s52, s23, 8192
    s_add_u32 s53, s23, 12288
    s_waitcnt lgkmcnt(3)
    v_mfma_f32_32x32x16_bf16 v[100:115], v[84:87], v[68:71], 0
    s_waitcnt lgkmcnt(2)
    v_mfma_f32_32x32x16_bf16 v[100:115], v[88:91], v[72:75], v[100:115]
    s_waitcnt lgkmcnt(1)
    v_mfma_f32_32x32x16_bf16 v[100:115], v[92:95], v[76:79], v[100:115]
    s_waitcnt lgkmcnt(0)
    v_mfma_f32_32x32x16_bf16 v[100:115], v[96:99], v[80:83], v[100:115]
    s_nop 11
    v_add_f32 v254, 0x358637bd, v100
    v_rcp_f32 v254, v254
    s_nop 0
    v_mul_f32 v254, v254, v221
    v_pk_mul_f32 v[100:101], v[100:101], v[254:255] op_sel_hi:[1,0]
    v_pk_mul_f32 v[102:103], v[102:103], v[254:255] op_sel_hi:[1,0]
    v_pk_mul_f32 v[104:105], v[104:105], v[254:255] op_sel_hi:[1,0]
    v_pk_mul_f32 v[106:107], v[106:107], v[254:255] op_sel_hi:[1,0]
    v_cvt_pk_bf16_f32 v124, v198, v101
    v_cvt_pk_bf16_f32 v125, v102, v103
    v_cvt_pk_bf16_f32 v126, v104, v105
    v_cvt_pk_bf16_f32 v127, v106, v107
    buffer_store_dwordx4 v[124:127], v183, s[28:31], s20 offen offset:0 sc1
    v_pk_mul_f32 v[108:109], v[108:109], v[254:255] op_sel_hi:[1,0]
    v_pk_mul_f32 v[110:111], v[110:111], v[254:255] op_sel_hi:[1,0]
    v_pk_mul_f32 v[112:113], v[112:113], v[254:255] op_sel_hi:[1,0]
    v_pk_mul_f32 v[114:115], v[114:115], v[254:255] op_sel_hi:[1,0]
    v_cvt_pk_bf16_f32 v128, v198, v109
    v_cvt_pk_bf16_f32 v129, v110, v111
    v_cvt_pk_bf16_f32 v130, v112, v113
    v_cvt_pk_bf16_f32 v131, v114, v115
    buffer_store_dwordx4 v[128:131], v183, s[28:31], s20 offen offset:512 sc1
    s_add_u32 s48, s21, 0x3c00
    s_add_u32 s49, s21, 0x7800
    s_add_u32 s50, s21, 0xb400
    v_lshlrev_b32 v223, 2, v215
    s_waitcnt vmcnt(2)
    v_cmp_ne_u32 vcc, s37, v251
    s_nop 0
    s_cmp_eq_u64 vcc, 0
    s_cselect_b32 s38, 28, 0
    s_cmp_lt_u32 s64, s38
    s_cselect_b64 s[8:9], -1, 0
    s_mov_b64 exec, s[8:9]
    s_add_u32 m0, s56, 0x4000
    s_nop 0
    buffer_load_dwordx4 v180, s[28:31], s21 offen offset:0 sc1 lds
    buffer_load_dwordx4 v180, s[28:31], s48 offen offset:1024 sc1 lds
    buffer_load_dwordx4 v180, s[28:31], s49 offen offset:2048 sc1 lds
    buffer_load_dwordx4 v180, s[28:31], s50 offen offset:3072 sc1 lds
    buffer_load_dword v253, v223, s[28:31], s22 offen sc1
    s_not_b64 exec, exec
    buffer_load_dword v251, v181, s[28:31], 0 offen sc1
    s_mov_b64 exec, -1
    s_cmp_ge_u32 s64, 28
    s_cbranch_scc1 .Lidle
    ds_read_b64_tr_b16 a[192:193], v232 offset:28672
    ds_read_b64_tr_b16 a[194:195], v232 offset:29184
    ds_read_b64_tr_b16 a[196:197], v233 offset:28672
    ds_read_b64_tr_b16 a[198:199], v233 offset:29184
    ds_read_b64_tr_b16 a[200:201], v234 offset:28672
    ds_read_b64_tr_b16 a[202:203], v234 offset:29184
    ds_read_b64_tr_b16 a[204:205], v235 offset:28672
    ds_read_b64_tr_b16 a[206:207], v235 offset:29184
    ds_read_b64_tr_b16 a[208:209], v232 offset:8192
    ds_read_b64_tr_b16 a[210:211], v232 offset:8704
    ds_read_b64_tr_b16 a[212:213], v233 offset:8192
    ds_read_b64_tr_b16 a[214:215], v233 offset:8704
    ds_read_b64_tr_b16 a[216:217], v234 offset:8192
    ds_read_b64_tr_b16 a[218:219], v234 offset:8704
    ds_read_b64_tr_b16 a[220:221], v235 offset:8192
    ds_read_b64_tr_b16 a[222:223], v235 offset:8704
    ds_read_b64_tr_b16 a[224:225], v232 offset:16384
    ds_read_b64_tr_b16 a[226:227], v232 offset:16896
    ds_read_b64_tr_b16 a[228:229], v233 offset:16384
    ds_read_b64_tr_b16 a[230:231], v233 offset:16896
    ds_read_b64_tr_b16 a[232:233], v234 offset:16384
    ds_read_b64_tr_b16 a[234:235], v234 offset:16896
    ds_read_b64_tr_b16 a[236:237], v235 offset:16384
    ds_read_b64_tr_b16 a[238:239], v235 offset:16896
    ds_read_b64_tr_b16 a[240:241], v232 offset:24576
    ds_read_b64_tr_b16 a[242:243], v232 offset:25088
    ds_read_b64_tr_b16 a[244:245], v233 offset:24576
    ds_read_b64_tr_b16 a[246:247], v233 offset:25088
    ds_read_b64_tr_b16 a[248:249], v234 offset:24576
    ds_read_b64_tr_b16 a[250:251], v234 offset:25088
    ds_read_b64_tr_b16 a[252:253], v235 offset:24576
    ds_read_b64_tr_b16 a[254:255], v235 offset:25088
    ds_read_b64_tr_b16 a[0:1], v232 offset:32768
    ds_read_b64_tr_b16 a[2:3], v232 offset:33280
    ds_read_b64_tr_b16 a[4:5], v233 offset:32768
    ds_read_b64_tr_b16 a[6:7], v233 offset:33280
    ds_read_b64_tr_b16 a[8:9], v234 offset:32768
    ds_read_b64_tr_b16 a[10:11], v234 offset:33280
    ds_read_b64_tr_b16 a[12:13], v235 offset:32768
    ds_read_b64_tr_b16 a[14:15], v235 offset:33280
    ds_read_b64_tr_b16 a[16:17], v232 offset:40960
    ds_read_b64_tr_b16 a[18:19], v232 offset:41472
    ds_read_b64_tr_b16 a[20:21], v233 offset:40960
    ds_read_b64_tr_b16 a[22:23], v233 offset:41472
    ds_read_b64_tr_b16 a[24:25], v234 offset:40960
    ds_read_b64_tr_b16 a[26:27], v234 offset:41472
    ds_read_b64_tr_b16 a[28:29], v235 offset:40960
    ds_read_b64_tr_b16 a[30:31], v235 offset:41472
    ds_read_b64_tr_b16 a[32:33], v232 offset:49152
    ds_read_b64_tr_b16 a[34:35], v232 offset:49664
    ds_read_b64_tr_b16 a[36:37], v233 offset:49152
    ds_read_b64_tr_b16 a[38:39], v233 offset:49664
    ds_read_b64_tr_b16 a[40:41], v234 offset:49152
    ds_read_b64_tr_b16 a[42:43], v234 offset:49664
    ds_read_b64_tr_b16 a[44:45], v235 offset:49152
    ds_read_b64_tr_b16 a[46:47], v235 offset:49664
    ds_read_b64_tr_b16 a[48:49], v232 offset:57344
    ds_read_b64_tr_b16 a[50:51], v232 offset:57856
    ds_read_b64_tr_b16 a[52:53], v233 offset:57344
    ds_read_b64_tr_b16 a[54:55], v233 offset:57856
    ds_read_b64_tr_b16 a[56:57], v234 offset:57344
    ds_read_b64_tr_b16 a[58:59], v234 offset:57856
    ds_read_b64_tr_b16 a[60:61], v235 offset:57344
    ds_read_b64_tr_b16 a[62:63], v235 offset:57856
    ds_read_b64_tr_b16 a[64:65], v232 offset:61440
    ds_read_b64_tr_b16 a[66:67], v232 offset:61952
    ds_read_b64_tr_b16 a[68:69], v233 offset:61440
    ds_read_b64_tr_b16 a[70:71], v233 offset:61952
    ds_read_b64_tr_b16 a[72:73], v234 offset:61440
    ds_read_b64_tr_b16 a[74:75], v234 offset:61952
    ds_read_b64_tr_b16 a[76:77], v235 offset:61440
    ds_read_b64_tr_b16 a[78:79], v235 offset:61952
    ds_read_b64_tr_b16 a[80:81], v232 offset:36864
    ds_read_b64_tr_b16 a[82:83], v232 offset:37376
    ds_read_b64_tr_b16 a[84:85], v233 offset:36864
    ds_read_b64_tr_b16 a[86:87], v233 offset:37376
    ds_read_b64_tr_b16 a[88:89], v234 offset:36864
    ds_read_b64_tr_b16 a[90:91], v234 offset:37376
    ds_read_b64_tr_b16 a[92:93], v235 offset:36864
    ds_read_b64_tr_b16 a[94:95], v235 offset:37376
    ds_read_b64_tr_b16 a[96:97], v232 offset:45056
    ds_read_b64_tr_b16 a[98:99], v232 offset:45568
    ds_read_b64_tr_b16 a[100:101], v233 offset:45056
    ds_read_b64_tr_b16 a[102:103], v233 offset:45568
    ds_read_b64_tr_b16 a[104:105], v234 offset:45056
    ds_read_b64_tr_b16 a[106:107], v234 offset:45568
    ds_read_b64_tr_b16 a[108:109], v235 offset:45056
    ds_read_b64_tr_b16 a[110:111], v235 offset:45568
    ds_read_b64_tr_b16 a[112:113], v232 offset:53248
    ds_read_b64_tr_b16 a[114:115], v232 offset:53760
    ds_read_b64_tr_b16 a[116:117], v233 offset:53248
    ds_read_b64_tr_b16 a[118:119], v233 offset:53760
    ds_read_b64_tr_b16 a[120:121], v234 offset:53248
    ds_read_b64_tr_b16 a[122:123], v234 offset:53760
    ds_read_b64_tr_b16 a[124:125], v235 offset:53248
    ds_read_b64_tr_b16 a[126:127], v235 offset:53760
    s_cmp_lg_u64 s[8:9], 0
    s_cbranch_scc0 .Lz_slow
.Lz_join:
    s_waitcnt vmcnt(2)
    s_barrier
    ds_read_b128 v[68:71], v218 offset:16384
    ds_read_b128 v[84:87], v218 offset:20480
    ds_read_b128 v[100:103], v218 offset:24576
    ds_read_b128 v[116:119], v218 offset:28672
    ds_read_b128 v[72:75], v218 offset:17408
    buffer_load_dwordx4 v[4:7], v218, s[28:31], s23 offen offset:0 sc1
    ds_read_b128 v[88:91], v218 offset:21504
    ds_read_b128 v[104:107], v218 offset:25600
    buffer_load_dwordx4 v[8:11], v218, s[28:31], s23 offen offset:1024 sc1
    ds_read_b128 v[120:123], v218 offset:29696
    ds_read_b128 v[76:79], v218 offset:18432
    buffer_load_dwordx4 v[12:15], v218, s[28:31], s23 offen offset:3072 sc1
    ds_read_b128 v[92:95], v218 offset:22528
    ds_read_b128 v[108:111], v218 offset:26624
    buffer_load_dwordx4 v[16:19], v218, s[28:31], s51 offen offset:1024 sc1
    ds_read_b128 v[124:127], v218 offset:30720
    ds_read_b128 v[80:83], v218 offset:19456
    buffer_load_dwordx4 v[20:23], v218, s[28:31], s51 offen offset:3072 sc1
    ds_read_b128 v[96:99], v218 offset:23552
    ds_read_b128 v[112:115], v218 offset:27648
    buffer_load_dwordx4 v[24:27], v218, s[28:31], s23 offen offset:2048 sc1
    ds_read_b128 v[128:131], v218 offset:31744
    s_waitcnt lgkmcnt(14)
    v_mfma_f32_16x16x32_bf16 v[164:167], v[68:71], v[132:135], 0
    v_mfma_f32_16x16x32_bf16 v[168:171], v[84:87], v[132:135], 0
    s_waitcnt lgkmcnt(13)
    v_mfma_f32_16x16x32_bf16 v[172:175], v[100:103], v[148:151], 0
    s_waitcnt lgkmcnt(12)
    v_mfma_f32_16x16x32_bf16 v[176:179], v[116:119], v[148:151], 0
    s_waitcnt lgkmcnt(11)
    v_mfma_f32_16x16x32_bf16 v[164:167], v[72:75], v[136:139], v[164:167]
    s_waitcnt lgkmcnt(10)
    v_mfma_f32_16x16x32_bf16 v[168:171], v[88:91], v[136:139], v[168:171]
    s_waitcnt lgkmcnt(9)
    v_mfma_f32_16x16x32_bf16 v[172:175], v[104:107], v[152:155], v[172:175]
    s_waitcnt lgkmcnt(8)
    v_mfma_f32_16x16x32_bf16 v[176:179], v[120:123], v[152:155], v[176:179]
    s_waitcnt lgkmcnt(7)
    v_mfma_f32_16x16x32_bf16 v[164:167], v[76:79], v[140:143], v[164:167]
    s_waitcnt lgkmcnt(6)
    v_mfma_f32_16x16x32_bf16 v[168:171], v[92:95], v[140:143], v[168:171]
    s_waitcnt lgkmcnt(5)
    v_mfma_f32_16x16x32_bf16 v[172:175], v[108:111], v[156:159], v[172:175]
    s_waitcnt lgkmcnt(4)
    v_mfma_f32_16x16x32_bf16 v[176:179], v[124:127], v[156:159], v[176:179]
    s_waitcnt lgkmcnt(3)
    v_mfma_f32_16x16x32_bf16 v[164:167], v[80:83], v[144:147], v[164:167]
    s_waitcnt lgkmcnt(2)
    v_mfma_f32_16x16x32_bf16 v[168:171], v[96:99], v[144:147], v[168:171]
    buffer_load_dwordx4 v[28:31], v218, s[28:31], s51 offen offset:0 sc1
    s_waitcnt lgkmcnt(1)
    v_mfma_f32_16x16x32_bf16 v[172:175], v[112:115], v[160:163], v[172:175]
    buffer_load_dwordx4 v[32:35], v218, s[28:31], s51 offen offset:2048 sc1
    s_waitcnt lgkmcnt(0)
    v_mfma_f32_16x16x32_bf16 v[176:179], v[128:131], v[160:163], v[176:179]
    buffer_load_dwordx4 v[36:39], v218, s[28:31], s52 offen offset:0 sc1
    buffer_load_dwordx4 v[40:43], v218, s[28:31], s52 offen offset:2048 sc1
    buffer_load_dwordx4 v[44:47], v218, s[28:31], s53 offen offset:0 sc1
    buffer_load_dwordx4 v[48:51], v218, s[28:31], s53 offen offset:2048 sc1
    s_mov_b32 s65, 0x8000
    s_mov_b32 s3, 0
    s_waitcnt vmcnt(8)
    v_cmp_ne_u16_e64 s[40:41], s61, v4
    v_mul_f32 v164, v164, v253
    v_cmp_ne_u16_e64 s[42:43], s61, v8
    v_mul_f32 v165, v165, v253
    v_cmp_ne_u16_e64 s[44:45], s61, v12
    v_mul_f32 v166, v166, v253
    v_cmp_ne_u16_e64 s[46:47], s61, v16
    v_mul_f32 v167, v167, v253
    s_or_b64 s[40:41], s[40:41], s[42:43]
    v_mul_f32 v168, v168, v253
    s_or_b64 s[44:45], s[44:45], s[46:47]
    s_or_b64 s[40:41], s[40:41], s[44:45]
    v_mul_f32 v169, v169, v253
    v_mul_f32 v170, v170, v253
    v_mul_f32 v171, v171, v253
    v_mul_f32 v172, v172, v253
    v_mul_f32 v173, v173, v253
    v_mul_f32 v174, v174, v253
    v_mul_f32 v175, v175, v253
    v_mul_f32 v176, v176, v253
    v_mul_f32 v177, v177, v253
    v_mul_f32 v178, v178, v253
    v_mul_f32 v179, v179, v253
    s_cbranch_scc1 .Lo_miss0
    v_mfma_f32_16x16x32_bf16 v[164:167], a[128:131], v[4:7], v[164:167]
    buffer_load_dwordx4 v[52:55], v218, s[28:31], s53 offen offset:3072 sc1
    v_mfma_f32_16x16x32_bf16 v[168:171], a[132:135], v[4:7], v[168:171]
    v_mfma_f32_16x16x32_bf16 v[172:175], a[136:139], v[4:7], v[172:175]
    v_mfma_f32_16x16x32_bf16 v[176:179], a[140:143], v[4:7], v[176:179]
    buffer_load_dwordx4 v[56:59], v218, s[28:31], s52 offen offset:1024 sc1
    v_mfma_f32_16x16x32_bf16 v[164:167], a[144:147], v[8:11], v[164:167]
    v_mfma_f32_16x16x32_bf16 v[168:171], a[148:151], v[8:11], v[168:171]
    v_mfma_f32_16x16x32_bf16 v[172:175], a[152:155], v[8:11], v[172:175]
    buffer_load_dwordx4 v[60:63], v218, s[28:31], s52 offen offset:3072 sc1
    v_mfma_f32_16x16x32_bf16 v[176:179], a[156:159], v[8:11], v[176:179]
    v_mfma_f32_16x16x32_bf16 v[164:167], a[160:163], v[12:15], v[164:167]
    v_mfma_f32_16x16x32_bf16 v[168:171], a[164:167], v[12:15], v[168:171]
    buffer_load_dwordx4 v[64:67], v218, s[28:31], s53 offen offset:1024 sc1
    s_waitcnt vmcnt(8)
    v_cmp_ne_u16_e64 s[40:41], s61, v20
    v_mfma_f32_16x16x32_bf16 v[172:175], a[168:171], v[12:15], v[172:175]
    v_cmp_ne_u16_e64 s[42:43], s61, v24
    v_mfma_f32_16x16x32_bf16 v[176:179], a[172:175], v[12:15], v[176:179]
    v_cmp_ne_u16_e64 s[44:45], s61, v28
    v_mfma_f32_16x16x32_bf16 v[164:167], a[176:179], v[16:19], v[164:167]
    v_cmp_ne_u16_e64 s[46:47], s61, v32
    v_mfma_f32_16x16x32_bf16 v[168:171], a[180:183], v[16:19], v[168:171]
    s_or_b64 s[40:41], s[40:41], s[42:43]
    v_mfma_f32_16x16x32_bf16 v[172:175], a[184:187], v[16:19], v[172:175]
    s_or_b64 s[44:45], s[44:45], s[46:47]
    s_or_b64 s[40:41], s[40:41], s[44:45]
    v_mfma_f32_16x16x32_bf16 v[176:179], a[188:191], v[16:19], v[176:179]
.Lo_br1:
    s_cbranch_scc1 .Lo_miss1
    v_mfma_f32_16x16x32_bf16 v[164:167], a[192:195], v[20:23], v[164:167]
    v_mfma_f32_16x16x32_bf16 v[168:171], a[196:199], v[20:23], v[168:171]
    v_mfma_f32_16x16x32_bf16 v[172:175], a[200:203], v[20:23], v[172:175]
    v_mfma_f32_16x16x32_bf16 v[176:179], a[204:207], v[20:23], v[176:179]
    v_mfma_f32_16x16x32_bf16 v[164:167], a[208:211], v[24:27], v[164:167]
    v_mfma_f32_16x16x32_bf16 v[168:171], a[212:215], v[24:27], v[168:171]
    v_mfma_f32_16x16x32_bf16 v[172:175], a[216:219], v[24:27], v[172:175]
    v_mfma_f32_16x16x32_bf16 v[176:179], a[220:223], v[24:27], v[176:179]
    v_mfma_f32_16x16x32_bf16 v[164:167], a[224:227], v[28:31], v[164:167]
    v_mfma_f32_16x16x32_bf16 v[168:171], a[228:231], v[28:31], v[168:171]
    s_waitcnt vmcnt(4)
    v_cmp_ne_u16_e64 s[40:41], s61, v36
    v_mfma_f32_16x16x32_bf16 v[172:175], a[232:235], v[28:31], v[172:175]
    v_cmp_ne_u16_e64 s[42:43], s61, v40
    v_mfma_f32_16x16x32_bf16 v[176:179], a[236:239], v[28:31], v[176:179]
    v_cmp_ne_u16_e64 s[44:45], s61, v44
    v_mfma_f32_16x16x32_bf16 v[164:167], a[240:243], v[32:35], v[164:167]
    v_cmp_ne_u16_e64 s[46:47], s61, v48
    v_mfma_f32_16x16x32_bf16 v[168:171], a[244:247], v[32:35], v[168:171]
    s_or_b64 s[40:41], s[40:41], s[42:43]
    v_mfma_f32_16x16x32_bf16 v[172:175], a[248:251], v[32:35], v[172:175]
    s_or_b64 s[44:45], s[44:45], s[46:47]
    s_or_b64 s[40:41], s[40:41], s[44:45]
    v_mfma_f32_16x16x32_bf16 v[176:179], a[252:255], v[32:35], v[176:179]
.Lo_br2:
    s_cbranch_scc1 .Lo_miss2
    v_mfma_f32_16x16x32_bf16 v[164:167], a[0:3], v[36:39], v[164:167]
    v_mfma_f32_16x16x32_bf16 v[168:171], a[4:7], v[36:39], v[168:171]
    v_mfma_f32_16x16x32_bf16 v[172:175], a[8:11], v[36:39], v[172:175]
    v_mfma_f32_16x16x32_bf16 v[176:179], a[12:15], v[36:39], v[176:179]
    v_mfma_f32_16x16x32_bf16 v[164:167], a[16:19], v[40:43], v[164:167]
    v_mfma_f32_16x16x32_bf16 v[168:171], a[20:23], v[40:43], v[168:171]
    v_mfma_f32_16x16x32_bf16 v[172:175], a[24:27], v[40:43], v[172:175]
    v_mfma_f32_16x16x32_bf16 v[176:179], a[28:31], v[40:43], v[176:179]
    v_mfma_f32_16x16x32_bf16 v[164:167], a[32:35], v[44:47], v[164:167]
    v_mfma_f32_16x16x32_bf16 v[168:171], a[36:39], v[44:47], v[168:171]
    s_waitcnt vmcnt(0)
    v_cmp_ne_u16_e64 s[40:41], s61, v52
    v_mfma_f32_16x16x32_bf16 v[172:175], a[40:43], v[44:47], v[172:175]
    v_cmp_ne_u16_e64 s[42:43], s61, v56
    v_mfma_f32_16x16x32_bf16 v[176:179], a[44:47], v[44:47], v[176:179]
    v_cmp_ne_u16_e64 s[44:45], s61, v60
    v_mfma_f32_16x16x32_bf16 v[164:167], a[48:51], v[48:51], v[164:167]
    v_cmp_ne_u16_e64 s[46:47], s61, v64
    v_mfma_f32_16x16x32_bf16 v[168:171], a[52:55], v[48:51], v[168:171]
    s_or_b64 s[40:41], s[40:41], s[42:43]
    v_mfma_f32_16x16x32_bf16 v[172:175], a[56:59], v[48:51], v[172:175]
    s_or_b64 s[44:45], s[44:45], s[46:47]
    s_or_b64 s[40:41], s[40:41], s[44:45]
    v_mfma_f32_16x16x32_bf16 v[176:179], a[60:63], v[48:51], v[176:179]
.Lo_br3:
    s_cbranch_scc1 .Lo_miss3
    v_mfma_f32_16x16x32_bf16 v[164:167], a[64:67], v[52:55], v[164:167]
    v_mfma_f32_16x16x32_bf16 v[168:171], a[68:71], v[52:55], v[168:171]
    v_mfma_f32_16x16x32_bf16 v[172:175], a[72:75], v[52:55], v[172:175]
    v_mfma_f32_16x16x32_bf16 v[176:179], a[76:79], v[52:55], v[176:179]
    v_mfma_f32_16x16x32_bf16 v[164:167], a[80:83], v[56:59], v[164:167]
    v_mfma_f32_16x16x32_bf16 v[168:171], a[84:87], v[56:59], v[168:171]
    v_mfma_f32_16x16x32_bf16 v[172:175], a[88:91], v[56:59], v[172:175]
    v_mfma_f32_16x16x32_bf16 v[176:179], a[92:95], v[56:59], v[176:179]
    v_mfma_f32_16x16x32_bf16 v[164:167], a[96:99], v[60:63], v[164:167]
    v_mfma_f32_16x16x32_bf16 v[168:171], a[100:103], v[60:63], v[168:171]
    v_mfma_f32_16x16x32_bf16 v[172:175], a[104:107], v[60:63], v[172:175]
    v_mfma_f32_16x16x32_bf16 v[176:179], a[108:111], v[60:63], v[176:179]
    v_mfma_f32_16x16x32_bf16 v[164:167], a[112:115], v[64:67], v[164:167]
    v_mfma_f32_16x16x32_bf16 v[168:171], a[116:119], v[64:67], v[168:171]
    v_mfma_f32_16x16x32_bf16 v[172:175], a[120:123], v[64:67], v[172:175]
    v_mfma_f32_16x16x32_bf16 v[176:179], a[124:127], v[64:67], v[176:179]
.Lo_next3:
    s_cmp_lg_u32 s3, 0
    s_cbranch_scc1 .Lo_late
.Lo_done:
    s_nop 2
    v_cvt_pk_bf16_f32 v68, v164, v165
    v_cvt_pk_bf16_f32 v69, v166, v167
    v_cvt_pk_bf16_f32 v70, v168, v169
    v_cvt_pk_bf16_f32 v71, v170, v171
    s_nop 0
    v_permlane16_swap_b32 v68, v70
    v_permlane16_swap_b32 v69, v71
    buffer_store_dwordx4 v[68:71], v3, s[24:27], s36 offen offset:0 sc1
    v_cvt_pk_bf16_f32 v72, v172, v173
    v_cvt_pk_bf16_f32 v73, v174, v175
    v_cvt_pk_bf16_f32 v74, v176, v177
    v_cvt_pk_bf16_f32 v75, v178, v179
    s_nop 0
    v_permlane16_swap_b32 v72, v74
    v_permlane16_swap_b32 v73, v75
    buffer_store_dwordx4 v[72:75], v3, s[24:27], s36 offen offset:64 sc1
    s_or_b32 s38, s2, s32
    s_cmp_lg_u32 s38, 0
    s_cbranch_scc1 .Lfin
    s_mov_b32 exec_lo, 0x1
    s_mov_b32 exec_hi, 0x0
    buffer_store_dword v197, v196, s[28:31], 0 offen sc1
.Lfin:
.Lend:
    s_endpgm
.Lidle:
    s_waitcnt vmcnt(0)
    s_branch .Lfin
.La_miss0:
    v_cmp_ne_u16_e64 s[40:41], s61, v4
    v_cmp_ne_u16_e64 s[42:43], s61, v8
    v_cmp_ne_u16_e64 s[44:45], s61, v12
    v_cmp_ne_u16_e64 s[46:47], s61, v16
    s_cmp_lg_u64 s[40:41], 0
    s_cselect_b64 exec, -1, 0
    buffer_load_dwordx4 v[4:7], v185, s[28:31], s51 offen offset:0 sc1
    s_cmp_lg_u64 s[42:43], 0
    s_cselect_b64 exec, -1, 0
    buffer_load_dwordx4 v[8:11], v185, s[28:31], s51 offen offset:256 sc1
    s_cmp_lg_u64 s[44:45], 0
    s_cselect_b64 exec, -1, 0
    buffer_load_dwordx4 v[12:15], v249, s[28:31], s51 offen offset:0 sc1
    s_cmp_lg_u64 s[46:47], 0
    s_cselect_b64 exec, -1, 0
    buffer_load_dwordx4 v[16:19], v249, s[28:31], s51 offen offset:256 sc1
    s_mov_b64 exec, -1
    s_bitset1_b32 s3, 0
    s_branch .La_next0
.La_miss1:
    v_cmp_ne_u16_e64 s[40:41], s61, v20
    v_cmp_ne_u16_e64 s[42:43], s61, v24
    v_cmp_ne_u16_e64 s[44:45], s61, v28
    v_cmp_ne_u16_e64 s[46:47], s61, v32
    s_cmp_lg_u64 s[40:41], 0
    s_cselect_b64 exec, -1, 0
    buffer_load_dwordx4 v[20:23], v185, s[28:31], s52 offen offset:0 sc1
    s_cmp_lg_u64 s[42:43], 0
    s_cselect_b64 exec, -1, 0
    buffer_load_dwordx4 v[24:27], v185, s[28:31], s52 offen offset:256 sc1
    s_cmp_lg_u64 s[44:45], 0
    s_cselect_b64 exec, -1, 0
    buffer_load_dwordx4 v[28:31], v249, s[28:31], s52 offen offset:0 sc1
    s_cmp_lg_u64 s[46:47], 0
    s_cselect_b64 exec, -1, 0
    buffer_load_dwordx4 v[32:35], v249, s[28:31], s52 offen offset:256 sc1
    s_mov_b64 exec, -1
    s_bitset1_b32 s3, 1
    s_branch .La_next1
.La_miss2:
    v_cmp_ne_u16_e64 s[40:41], s61, v36
    v_cmp_ne_u16_e64 s[42:43], s61, v40
    v_cmp_ne_u16_e64 s[44:45], s61, v44
    v_cmp_ne_u16_e64 s[46:47], s61, v48
    s_cmp_lg_u64 s[40:41], 0
    s_cselect_b64 exec, -1, 0
    buffer_load_dwordx4 v[36:39], v185, s[28:31], s53 offen offset:0 sc1
    s_cmp_lg_u64 s[42:43], 0
    s_cselect_b64 exec, -1, 0
    buffer_load_dwordx4 v[40:43], v185, s[28:31], s53 offen offset:256 sc1
    s_cmp_lg_u64 s[44:45], 0
    s_cselect_b64 exec, -1, 0
    buffer_load_dwordx4 v[44:47], v249, s[28:31], s53 offen offset:0 sc1
    s_cmp_lg_u64 s[46:47], 0
    s_cselect_b64 exec, -1, 0
    buffer_load_dwordx4 v[48:51], v249, s[28:31], s53 offen offset:256 sc1
    s_mov_b64 exec, -1
    s_bitset1_b32 s3, 2
    s_branch .La_next2
.La_miss3:
    v_cmp_ne_u16_e64 s[40:41], s61, v52
    v_cmp_ne_u16_e64 s[42:43], s61, v56
    v_cmp_ne_u16_e64 s[44:45], s61, v60
    v_cmp_ne_u16_e64 s[46:47], s61, v64
    s_cmp_lg_u64 s[40:41], 0
    s_cselect_b64 exec, -1, 0
    buffer_load_dwordx4 v[52:55], v185, s[28:31], s54 offen offset:0 sc1
    s_cmp_lg_u64 s[42:43], 0
    s_cselect_b64 exec, -1, 0
    buffer_load_dwordx4 v[56:59], v185, s[28:31], s54 offen offset:256 sc1
    s_cmp_lg_u64 s[44:45], 0
    s_cselect_b64 exec, -1, 0
    buffer_load_dwordx4 v[60:63], v249, s[28:31], s54 offen offset:0 sc1
    s_cmp_lg_u64 s[46:47], 0
    s_cselect_b64 exec, -1, 0
    buffer_load_dwordx4 v[64:67], v249, s[28:31], s54 offen offset:256 sc1
    s_mov_b64 exec, -1
    s_bitset1_b32 s3, 3
    s_branch .La_next3
.La_late:
    s_waitcnt vmcnt(0)
    s_sub_u32 s65, s65, 1
    s_cbranch_scc1 .La_done
    s_bitcmp1_b32 s3, 0
    s_cbranch_scc0 .La_l0
    v_cmp_ne_u16_e64 s[40:41], s61, v4
    v_cmp_ne_u16_e64 s[42:43], s61, v8
    v_cmp_ne_u16_e64 s[44:45], s61, v12
    v_cmp_ne_u16_e64 s[46:47], s61, v16
    s_or_b64 s[40:41], s[40:41], s[42:43]
    s_or_b64 s[44:45], s[44:45], s[46:47]
    s_or_b64 s[40:41], s[40:41], s[44:45]
    s_cbranch_scc0 .La_lc0
    v_cmp_ne_u16_e64 s[40:41], s61, v4
    v_cmp_ne_u16_e64 s[42:43], s61, v8
    v_cmp_ne_u16_e64 s[44:45], s61, v12
    v_cmp_ne_u16_e64 s[46:47], s61, v16
    s_cmp_lg_u64 s[40:41], 0
    s_cselect_b64 exec, -1, 0
    buffer_load_dwordx4 v[4:7], v185, s[28:31], s51 offen offset:0 sc1
    s_cmp_lg_u64 s[42:43], 0
    s_cselect_b64 exec, -1, 0
    buffer_load_dwordx4 v[8:11], v185, s[28:31], s51 offen offset:256 sc1
    s_cmp_lg_u64 s[44:45], 0
    s_cselect_b64 exec, -1, 0
    buffer_load_dwordx4 v[12:15], v249, s[28:31], s51 offen offset:0 sc1
    s_cmp_lg_u64 s[46:47], 0
    s_cselect_b64 exec, -1, 0
    buffer_load_dwordx4 v[16:19], v249, s[28:31], s51 offen offset:256 sc1
    s_mov_b64 exec, -1
    s_branch .La_l0
.La_lc0:
    v_mfma_f32_16x16x32_bf16 v[116:119], v[236:239], v[4:7], v[116:119]
    v_mfma_f32_16x16x32_bf16 v[120:123], v[236:239], v[8:11], v[120:123]
    v_mfma_f32_16x16x32_bf16 v[116:119], v[236:239], v[12:15], v[116:119]
    v_mfma_f32_16x16x32_bf16 v[120:123], v[236:239], v[16:19], v[120:123]
    s_bitset0_b32 s3, 0
.La_l0:
    s_bitcmp1_b32 s3, 1
    s_cbranch_scc0 .La_l1
    v_cmp_ne_u16_e64 s[40:41], s61, v20
    v_cmp_ne_u16_e64 s[42:43], s61, v24
    v_cmp_ne_u16_e64 s[44:45], s61, v28
    v_cmp_ne_u16_e64 s[46:47], s61, v32
    s_or_b64 s[40:41], s[40:41], s[42:43]
    s_or_b64 s[44:45], s[44:45], s[46:47]
    s_or_b64 s[40:41], s[40:41], s[44:45]
    s_cbranch_scc0 .La_lc1
    v_cmp_ne_u16_e64 s[40:41], s61, v20
    v_cmp_ne_u16_e64 s[42:43], s61, v24
    v_cmp_ne_u16_e64 s[44:45], s61, v28
    v_cmp_ne_u16_e64 s[46:47], s61, v32
    s_cmp_lg_u64 s[40:41], 0
    s_cselect_b64 exec, -1, 0
    buffer_load_dwordx4 v[20:23], v185, s[28:31], s52 offen offset:0 sc1
    s_cmp_lg_u64 s[42:43], 0
    s_cselect_b64 exec, -1, 0
    buffer_load_dwordx4 v[24:27], v185, s[28:31], s52 offen offset:256 sc1
    s_cmp_lg_u64 s[44:45], 0
    s_cselect_b64 exec, -1, 0
    buffer_load_dwordx4 v[28:31], v249, s[28:31], s52 offen offset:0 sc1
    s_cmp_lg_u64 s[46:47], 0
    s_cselect_b64 exec, -1, 0
    buffer_load_dwordx4 v[32:35], v249, s[28:31], s52 offen offset:256 sc1
    s_mov_b64 exec, -1
    s_branch .La_l1
.La_lc1:
    v_mfma_f32_16x16x32_bf16 v[116:119], v[236:239], v[20:23], v[116:119]
    v_mfma_f32_16x16x32_bf16 v[120:123], v[236:239], v[24:27], v[120:123]
    v_mfma_f32_16x16x32_bf16 v[116:119], v[236:239], v[28:31], v[116:119]
    v_mfma_f32_16x16x32_bf16 v[120:123], v[236:239], v[32:35], v[120:123]
    s_bitset0_b32 s3, 1
.La_l1:
    s_bitcmp1_b32 s3, 2
    s_cbranch_scc0 .La_l2
    v_cmp_ne_u16_e64 s[40:41], s61, v36
    v_cmp_ne_u16_e64 s[42:43], s61, v40
    v_cmp_ne_u16_e64 s[44:45], s61, v44
    v_cmp_ne_u16_e64 s[46:47], s61, v48
    s_or_b64 s[40:41], s[40:41], s[42:43]
    s_or_b64 s[44:45], s[44:45], s[46:47]
    s_or_b64 s[40:41], s[40:41], s[44:45]
    s_cbranch_scc0 .La_lc2
    v_cmp_ne_u16_e64 s[40:41], s61, v36
    v_cmp_ne_u16_e64 s[42:43], s61, v40
    v_cmp_ne_u16_e64 s[44:45], s61, v44
    v_cmp_ne_u16_e64 s[46:47], s61, v48
    s_cmp_lg_u64 s[40:41], 0
    s_cselect_b64 exec, -1, 0
    buffer_load_dwordx4 v[36:39], v185, s[28:31], s53 offen offset:0 sc1
    s_cmp_lg_u64 s[42:43], 0
    s_cselect_b64 exec, -1, 0
    buffer_load_dwordx4 v[40:43], v185, s[28:31], s53 offen offset:256 sc1
    s_cmp_lg_u64 s[44:45], 0
    s_cselect_b64 exec, -1, 0
    buffer_load_dwordx4 v[44:47], v249, s[28:31], s53 offen offset:0 sc1
    s_cmp_lg_u64 s[46:47], 0
    s_cselect_b64 exec, -1, 0
    buffer_load_dwordx4 v[48:51], v249, s[28:31], s53 offen offset:256 sc1
    s_mov_b64 exec, -1
    s_branch .La_l2
.La_lc2:
    v_mfma_f32_16x16x32_bf16 v[116:119], v[236:239], v[36:39], v[116:119]
    v_mfma_f32_16x16x32_bf16 v[120:123], v[236:239], v[40:43], v[120:123]
    v_mfma_f32_16x16x32_bf16 v[116:119], v[236:239], v[44:47], v[116:119]
    v_mfma_f32_16x16x32_bf16 v[120:123], v[236:239], v[48:51], v[120:123]
    s_bitset0_b32 s3, 2
.La_l2:
    s_bitcmp1_b32 s3, 3
    s_cbranch_scc0 .La_l3
    v_cmp_ne_u16_e64 s[40:41], s61, v52
    v_cmp_ne_u16_e64 s[42:43], s61, v56
    v_cmp_ne_u16_e64 s[44:45], s61, v60
    v_cmp_ne_u16_e64 s[46:47], s61, v64
    s_or_b64 s[40:41], s[40:41], s[42:43]
    s_or_b64 s[44:45], s[44:45], s[46:47]
    s_or_b64 s[40:41], s[40:41], s[44:45]
    s_cbranch_scc0 .La_lc3
    v_cmp_ne_u16_e64 s[40:41], s61, v52
    v_cmp_ne_u16_e64 s[42:43], s61, v56
    v_cmp_ne_u16_e64 s[44:45], s61, v60
    v_cmp_ne_u16_e64 s[46:47], s61, v64
    s_cmp_lg_u64 s[40:41], 0
    s_cselect_b64 exec, -1, 0
    buffer_load_dwordx4 v[52:55], v185, s[28:31], s54 offen offset:0 sc1
    s_cmp_lg_u64 s[42:43], 0
    s_cselect_b64 exec, -1, 0
    buffer_load_dwordx4 v[56:59], v185, s[28:31], s54 offen offset:256 sc1
    s_cmp_lg_u64 s[44:45], 0
    s_cselect_b64 exec, -1, 0
    buffer_load_dwordx4 v[60:63], v249, s[28:31], s54 offen offset:0 sc1
    s_cmp_lg_u64 s[46:47], 0
    s_cselect_b64 exec, -1, 0
    buffer_load_dwordx4 v[64:67], v249, s[28:31], s54 offen offset:256 sc1
    s_mov_b64 exec, -1
    s_branch .La_l3
.La_lc3:
    v_mfma_f32_16x16x32_bf16 v[116:119], v[236:239], v[52:55], v[116:119]
    v_mfma_f32_16x16x32_bf16 v[120:123], v[236:239], v[56:59], v[120:123]
    v_mfma_f32_16x16x32_bf16 v[116:119], v[236:239], v[60:63], v[116:119]
    v_mfma_f32_16x16x32_bf16 v[120:123], v[236:239], v[64:67], v[120:123]
    s_bitset0_b32 s3, 3
.La_l3:
    s_cmp_lg_u32 s3, 0
    s_cbranch_scc1 .La_late
    s_branch .La_done
.Lz_slow:
    s_waitcnt vmcnt(0)
    v_cmp_ne_u32 vcc, s37, v251
    s_cbranch_vccz .Lz_ok
    s_mov_b32 s38, 0x8000
.Lz_poll:
    buffer_load_dword v251, v181, s[28:31], 0 offen sc1
    s_waitcnt vmcnt(0)
    v_cmp_ne_u32 vcc, s37, v251
    s_cbranch_vccz .Lz_ok
    s_sub_u32 s38, s38, 1
    s_cbranch_scc0 .Lz_poll
.Lz_ok:
    s_add_u32 m0, s56, 0x4000
    s_nop 0
    buffer_load_dwordx4 v180, s[28:31], s21 offen offset:0 sc1 lds
    buffer_load_dwordx4 v180, s[28:31], s48 offen offset:1024 sc1 lds
    buffer_load_dwordx4 v180, s[28:31], s49 offen offset:2048 sc1 lds
    buffer_load_dwordx4 v180, s[28:31], s50 offen offset:3072 sc1 lds
    buffer_load_dword v253, v223, s[28:31], s22 offen sc1
    s_waitcnt vmcnt(0)
    s_branch .Lz_join
.Lo_miss0:
    v_cmp_ne_u16_e64 s[40:41], s61, v4
    v_cmp_ne_u16_e64 s[42:43], s61, v8
    v_cmp_ne_u16_e64 s[44:45], s61, v12
    v_cmp_ne_u16_e64 s[46:47], s61, v16
    s_cmp_lg_u64 s[40:41], 0
    s_cselect_b64 exec, -1, 0
    buffer_load_dwordx4 v[4:7], v218, s[28:31], s23 offen offset:0 sc1
    s_cmp_lg_u64 s[42:43], 0
    s_cselect_b64 exec, -1, 0
    buffer_load_dwordx4 v[8:11], v218, s[28:31], s23 offen offset:1024 sc1
    s_cmp_lg_u64 s[44:45], 0
    s_cselect_b64 exec, -1, 0
    buffer_load_dwordx4 v[12:15], v218, s[28:31], s23 offen offset:3072 sc1
    s_cmp_lg_u64 s[46:47], 0
    s_cselect_b64 exec, -1, 0
    buffer_load_dwordx4 v[16:19], v218, s[28:31], s51 offen offset:1024 sc1
    s_mov_b64 exec, -1
    s_bitset1_b32 s3, 0
    buffer_load_dwordx4 v[52:55], v218, s[28:31], s53 offen offset:3072 sc1
    buffer_load_dwordx4 v[56:59], v218, s[28:31], s52 offen offset:1024 sc1
    buffer_load_dwordx4 v[60:63], v218, s[28:31], s52 offen offset:3072 sc1
    buffer_load_dwordx4 v[64:67], v218, s[28:31], s53 offen offset:1024 sc1
    s_waitcnt vmcnt(8)
    v_cmp_ne_u16_e64 s[40:41], s61, v20
    v_cmp_ne_u16_e64 s[42:43], s61, v24
    v_cmp_ne_u16_e64 s[44:45], s61, v28
    v_cmp_ne_u16_e64 s[46:47], s61, v32
    s_or_b64 s[40:41], s[40:41], s[42:43]
    s_or_b64 s[44:45], s[44:45], s[46:47]
    s_or_b64 s[40:41], s[40:41], s[44:45]
    s_branch .Lo_br1
.Lo_miss1:
    v_cmp_ne_u16_e64 s[40:41], s61, v20
    v_cmp_ne_u16_e64 s[42:43], s61, v24
    v_cmp_ne_u16_e64 s[44:45], s61, v28
    v_cmp_ne_u16_e64 s[46:47], s61, v32
    s_cmp_lg_u64 s[40:41], 0
    s_cselect_b64 exec, -1, 0
    buffer_load_dwordx4 v[20:23], v218, s[28:31], s51 offen offset:3072 sc1
    s_cmp_lg_u64 s[42:43], 0
    s_cselect_b64 exec, -1, 0
    buffer_load_dwordx4 v[24:27], v218, s[28:31], s23 offen offset:2048 sc1
    s_cmp_lg_u64 s[44:45], 0
    s_cselect_b64 exec, -1, 0
    buffer_load_dwordx4 v[28:31], v218, s[28:31], s51 offen offset:0 sc1
    s_cmp_lg_u64 s[46:47], 0
    s_cselect_b64 exec, -1, 0
    buffer_load_dwordx4 v[32:35], v218, s[28:31], s51 offen offset:2048 sc1
    s_mov_b64 exec, -1
    s_bitset1_b32 s3, 1
    s_waitcnt vmcnt(4)
    v_cmp_ne_u16_e64 s[40:41], s61, v36
    v_cmp_ne_u16_e64 s[42:43], s61, v40
    v_cmp_ne_u16_e64 s[44:45], s61, v44
    v_cmp_ne_u16_e64 s[46:47], s61, v48
    s_or_b64 s[40:41], s[40:41], s[42:43]
    s_or_b64 s[44:45], s[44:45], s[46:47]
    s_or_b64 s[40:41], s[40:41], s[44:45]
    s_branch .Lo_br2
.Lo_miss2:
    v_cmp_ne_u16_e64 s[40:41], s61, v36
    v_cmp_ne_u16_e64 s[42:43], s61, v40
    v_cmp_ne_u16_e64 s[44:45], s61, v44
    v_cmp_ne_u16_e64 s[46:47], s61, v48
    s_cmp_lg_u64 s[40:41], 0
    s_cselect_b64 exec, -1, 0
    buffer_load_dwordx4 v[36:39], v218, s[28:31], s52 offen offset:0 sc1
    s_cmp_lg_u64 s[42:43], 0
    s_cselect_b64 exec, -1, 0
    buffer_load_dwordx4 v[40:43], v218, s[28:31], s52 offen offset:2048 sc1
    s_cmp_lg_u64 s[44:45], 0
    s_cselect_b64 exec, -1, 0
    buffer_load_dwordx4 v[44:47], v218, s[28:31], s53 offen offset:0 sc1
    s_cmp_lg_u64 s[46:47], 0
    s_cselect_b64 exec, -1, 0
    buffer_load_dwordx4 v[48:51], v218, s[28:31], s53 offen offset:2048 sc1
    s_mov_b64 exec, -1
    s_bitset1_b32 s3, 2
    s_waitcnt vmcnt(0)
    v_cmp_ne_u16_e64 s[40:41], s61, v52
    v_cmp_ne_u16_e64 s[42:43], s61, v56
    v_cmp_ne_u16_e64 s[44:45], s61, v60
    v_cmp_ne_u16_e64 s[46:47], s61, v64
    s_or_b64 s[40:41], s[40:41], s[42:43]
    s_or_b64 s[44:45], s[44:45], s[46:47]
    s_or_b64 s[40:41], s[40:41], s[44:45]
    s_branch .Lo_br3
.Lo_miss3:
    v_cmp_ne_u16_e64 s[40:41], s61, v52
    v_cmp_ne_u16_e64 s[42:43], s61, v56
    v_cmp_ne_u16_e64 s[44:45], s61, v60
    v_cmp_ne_u16_e64 s[46:47], s61, v64
    s_cmp_lg_u64 s[40:41], 0
    s_cselect_b64 exec, -1, 0
    buffer_load_dwordx4 v[52:55], v218, s[28:31], s53 offen offset:3072 sc1
    s_cmp_lg_u64 s[42:43], 0
    s_cselect_b64 exec, -1, 0
    buffer_load_dwordx4 v[56:59], v218, s[28:31], s52 offen offset:1024 sc1
    s_cmp_lg_u64 s[44:45], 0
    s_cselect_b64 exec, -1, 0
    buffer_load_dwordx4 v[60:63], v218, s[28:31], s52 offen offset:3072 sc1
    s_cmp_lg_u64 s[46:47], 0
    s_cselect_b64 exec, -1, 0
    buffer_load_dwordx4 v[64:67], v218, s[28:31], s53 offen offset:1024 sc1
    s_mov_b64 exec, -1
    s_bitset1_b32 s3, 3
    s_branch .Lo_next3
.Lo_late:
    s_waitcnt vmcnt(0)
    s_sub_u32 s65, s65, 1
    s_cbranch_scc1 .Lo_done
    s_bitcmp1_b32 s3, 0
    s_cbranch_scc0 .Lo_l0
    v_cmp_ne_u16_e64 s[40:41], s61, v4
    v_cmp_ne_u16_e64 s[42:43], s61, v8
    v_cmp_ne_u16_e64 s[44:45], s61, v12
    v_cmp_ne_u16_e64 s[46:47], s61, v16
    s_or_b64 s[40:41], s[40:41], s[42:43]
    s_or_b64 s[44:45], s[44:45], s[46:47]
    s_or_b64 s[40:41], s[40:41], s[44:45]
    s_cbranch_scc0 .Lo_lc0
    v_cmp_ne_u16_e64 s[40:41], s61, v4
    v_cmp_ne_u16_e64 s[42:43], s61, v8
    v_cmp_ne_u16_e64 s[44:45], s61, v12
    v_cmp_ne_u16_e64 s[46:47], s61, v16
    s_cmp_lg_u64 s[40:41], 0
    s_cselect_b64 exec, -1, 0
    buffer_load_dwordx4 v[4:7], v218, s[28:31], s23 offen offset:0 sc1
    s_cmp_lg_u64 s[42:43], 0
    s_cselect_b64 exec, -1, 0
    buffer_load_dwordx4 v[8:11], v218, s[28:31], s23 offen offset:1024 sc1
    s_cmp_lg_u64 s[44:45], 0
    s_cselect_b64 exec, -1, 0
    buffer_load_dwordx4 v[12:15], v218, s[28:31], s23 offen offset:3072 sc1
    s_cmp_lg_u64 s[46:47], 0
    s_cselect_b64 exec, -1, 0
    buffer_load_dwordx4 v[16:19], v218, s[28:31], s51 offen offset:1024 sc1
    s_mov_b64 exec, -1
    s_branch .Lo_l0
.Lo_lc0:
    v_mfma_f32_16x16x32_bf16 v[164:167], a[128:131], v[4:7], v[164:167]
    v_mfma_f32_16x16x32_bf16 v[168:171], a[132:135], v[4:7], v[168:171]
    v_mfma_f32_16x16x32_bf16 v[172:175], a[136:139], v[4:7], v[172:175]
    v_mfma_f32_16x16x32_bf16 v[176:179], a[140:143], v[4:7], v[176:179]
    v_mfma_f32_16x16x32_bf16 v[164:167], a[144:147], v[8:11], v[164:167]
    v_mfma_f32_16x16x32_bf16 v[168:171], a[148:151], v[8:11], v[168:171]
    v_mfma_f32_16x16x32_bf16 v[172:175], a[152:155], v[8:11], v[172:175]
    v_mfma_f32_16x16x32_bf16 v[176:179], a[156:159], v[8:11], v[176:179]
    v_mfma_f32_16x16x32_bf16 v[164:167], a[160:163], v[12:15], v[164:167]
    v_mfma_f32_16x16x32_bf16 v[168:171], a[164:167], v[12:15], v[168:171]
    v_mfma_f32_16x16x32_bf16 v[172:175], a[168:171], v[12:15], v[172:175]
    v_mfma_f32_16x16x32_bf16 v[176:179], a[172:175], v[12:15], v[176:179]
    v_mfma_f32_16x16x32_bf16 v[164:167], a[176:179], v[16:19], v[164:167]
    v_mfma_f32_16x16x32_bf16 v[168:171], a[180:183], v[16:19], v[168:171]
    v_mfma_f32_16x16x32_bf16 v[172:175], a[184:187], v[16:19], v[172:175]
    v_mfma_f32_16x16x32_bf16 v[176:179], a[188:191], v[16:19], v[176:179]
    s_bitset0_b32 s3, 0
.Lo_l0:
    s_bitcmp1_b32 s3, 1
    s_cbranch_scc0 .Lo_l1
    v_cmp_ne_u16_e64 s[40:41], s61, v20
    v_cmp_ne_u16_e64 s[42:43], s61, v24
    v_cmp_ne_u16_e64 s[44:45], s61, v28
    v_cmp_ne_u16_e64 s[46:47], s61, v32
    s_or_b64 s[40:41], s[40:41], s[42:43]
    s_or_b64 s[44:45], s[44:45], s[46:47]
    s_or_b64 s[40:41], s[40:41], s[44:45]
    s_cbranch_scc0 .Lo_lc1
    v_cmp_ne_u16_e64 s[40:41], s61, v20
    v_cmp_ne_u16_e64 s[42:43], s61, v24
    v_cmp_ne_u16_e64 s[44:45], s61, v28
    v_cmp_ne_u16_e64 s[46:47], s61, v32
    s_cmp_lg_u64 s[40:41], 0
    s_cselect_b64 exec, -1, 0
    buffer_load_dwordx4 v[20:23], v218, s[28:31], s51 offen offset:3072 sc1
    s_cmp_lg_u64 s[42:43], 0
    s_cselect_b64 exec, -1, 0
    buffer_load_dwordx4 v[24:27], v218, s[28:31], s23 offen offset:2048 sc1
    s_cmp_lg_u64 s[44:45], 0
    s_cselect_b64 exec, -1, 0
    buffer_load_dwordx4 v[28:31], v218, s[28:31], s51 offen offset:0 sc1
    s_cmp_lg_u64 s[46:47], 0
    s_cselect_b64 exec, -1, 0
    buffer_load_dwordx4 v[32:35], v218, s[28:31], s51 offen offset:2048 sc1
    s_mov_b64 exec, -1
    s_branch .Lo_l1
.Lo_lc1:
    v_mfma_f32_16x16x32_bf16 v[164:167], a[192:195], v[20:23], v[164:167]
    v_mfma_f32_16x16x32_bf16 v[168:171], a[196:199], v[20:23], v[168:171]
    v_mfma_f32_16x16x32_bf16 v[172:175], a[200:203], v[20:23], v[172:175]
    v_mfma_f32_16x16x32_bf16 v[176:179], a[204:207], v[20:23], v[176:179]
    v_mfma_f32_16x16x32_bf16 v[164:167], a[208:211], v[24:27], v[164:167]
    v_mfma_f32_16x16x32_bf16 v[168:171], a[212:215], v[24:27], v[168:171]
    v_mfma_f32_16x16x32_bf16 v[172:175], a[216:219], v[24:27], v[172:175]
    v_mfma_f32_16x16x32_bf16 v[176:179], a[220:223], v[24:27], v[176:179]
    v_mfma_f32_16x16x32_bf16 v[164:167], a[224:227], v[28:31], v[164:167]
    v_mfma_f32_16x16x32_bf16 v[168:171], a[228:231], v[28:31], v[168:171]
    v_mfma_f32_16x16x32_bf16 v[172:175], a[232:235], v[28:31], v[172:175]
    v_mfma_f32_16x16x32_bf16 v[176:179], a[236:239], v[28:31], v[176:179]
    v_mfma_f32_16x16x32_bf16 v[164:167], a[240:243], v[32:35], v[164:167]
    v_mfma_f32_16x16x32_bf16 v[168:171], a[244:247], v[32:35], v[168:171]
    v_mfma_f32_16x16x32_bf16 v[172:175], a[248:251], v[32:35], v[172:175]
    v_mfma_f32_16x16x32_bf16 v[176:179], a[252:255], v[32:35], v[176:179]
    s_bitset0_b32 s3, 1
.Lo_l1:
    s_bitcmp1_b32 s3, 2
    s_cbranch_scc0 .Lo_l2
    v_cmp_ne_u16_e64 s[40:41], s61, v36
    v_cmp_ne_u16_e64 s[42:43], s61, v40
    v_cmp_ne_u16_e64 s[44:45], s61, v44
    v_cmp_ne_u16_e64 s[46:47], s61, v48
    s_or_b64 s[40:41], s[40:41], s[42:43]
    s_or_b64 s[44:45], s[44:45], s[46:47]
    s_or_b64 s[40:41], s[40:41], s[44:45]
    s_cbranch_scc0 .Lo_lc2
    v_cmp_ne_u16_e64 s[40:41], s61, v36
    v_cmp_ne_u16_e64 s[42:43], s61, v40
    v_cmp_ne_u16_e64 s[44:45], s61, v44
    v_cmp_ne_u16_e64 s[46:47], s61, v48
    s_cmp_lg_u64 s[40:41], 0
    s_cselect_b64 exec, -1, 0
    buffer_load_dwordx4 v[36:39], v218, s[28:31], s52 offen offset:0 sc1
    s_cmp_lg_u64 s[42:43], 0
    s_cselect_b64 exec, -1, 0
    buffer_load_dwordx4 v[40:43], v218, s[28:31], s52 offen offset:2048 sc1
    s_cmp_lg_u64 s[44:45], 0
    s_cselect_b64 exec, -1, 0
    buffer_load_dwordx4 v[44:47], v218, s[28:31], s53 offen offset:0 sc1
    s_cmp_lg_u64 s[46:47], 0
    s_cselect_b64 exec, -1, 0
    buffer_load_dwordx4 v[48:51], v218, s[28:31], s53 offen offset:2048 sc1
    s_mov_b64 exec, -1
    s_branch .Lo_l2
.Lo_lc2:
    v_mfma_f32_16x16x32_bf16 v[164:167], a[0:3], v[36:39], v[164:167]
    v_mfma_f32_16x16x32_bf16 v[168:171], a[4:7], v[36:39], v[168:171]
    v_mfma_f32_16x16x32_bf16 v[172:175], a[8:11], v[36:39], v[172:175]
    v_mfma_f32_16x16x32_bf16 v[176:179], a[12:15], v[36:39], v[176:179]
    v_mfma_f32_16x16x32_bf16 v[164:167], a[16:19], v[40:43], v[164:167]
    v_mfma_f32_16x16x32_bf16 v[168:171], a[20:23], v[40:43], v[168:171]
    v_mfma_f32_16x16x32_bf16 v[172:175], a[24:27], v[40:43], v[172:175]
    v_mfma_f32_16x16x32_bf16 v[176:179], a[28:31], v[40:43], v[176:179]
    v_mfma_f32_16x16x32_bf16 v[164:167], a[32:35], v[44:47], v[164:167]
    v_mfma_f32_16x16x32_bf16 v[168:171], a[36:39], v[44:47], v[168:171]
    v_mfma_f32_16x16x32_bf16 v[172:175], a[40:43], v[44:47], v[172:175]
    v_mfma_f32_16x16x32_bf16 v[176:179], a[44:47], v[44:47], v[176:179]
    v_mfma_f32_16x16x32_bf16 v[164:167], a[48:51], v[48:51], v[164:167]
    v_mfma_f32_16x16x32_bf16 v[168:171], a[52:55], v[48:51], v[168:171]
    v_mfma_f32_16x16x32_bf16 v[172:175], a[56:59], v[48:51], v[172:175]
    v_mfma_f32_16x16x32_bf16 v[176:179], a[60:63], v[48:51], v[176:179]
    s_bitset0_b32 s3, 2
.Lo_l2:
    s_bitcmp1_b32 s3, 3
    s_cbranch_scc0 .Lo_l3
    v_cmp_ne_u16_e64 s[40:41], s61, v52
    v_cmp_ne_u16_e64 s[42:43], s61, v56
    v_cmp_ne_u16_e64 s[44:45], s61, v60
    v_cmp_ne_u16_e64 s[46:47], s61, v64
    s_or_b64 s[40:41], s[40:41], s[42:43]
    s_or_b64 s[44:45], s[44:45], s[46:47]
    s_or_b64 s[40:41], s[40:41], s[44:45]
    s_cbranch_scc0 .Lo_lc3
    v_cmp_ne_u16_e64 s[40:41], s61, v52
    v_cmp_ne_u16_e64 s[42:43], s61, v56
    v_cmp_ne_u16_e64 s[44:45], s61, v60
    v_cmp_ne_u16_e64 s[46:47], s61, v64
    s_cmp_lg_u64 s[40:41], 0
    s_cselect_b64 exec, -1, 0
    buffer_load_dwordx4 v[52:55], v218, s[28:31], s53 offen offset:3072 sc1
    s_cmp_lg_u64 s[42:43], 0
    s_cselect_b64 exec, -1, 0
    buffer_load_dwordx4 v[56:59], v218, s[28:31], s52 offen offset:1024 sc1
    s_cmp_lg_u64 s[44:45], 0
    s_cselect_b64 exec, -1, 0
    buffer_load_dwordx4 v[60:63], v218, s[28:31], s52 offen offset:3072 sc1
    s_cmp_lg_u64 s[46:47], 0
    s_cselect_b64 exec, -1, 0
    buffer_load_dwordx4 v[64:67], v218, s[28:31], s53 offen offset:1024 sc1
    s_mov_b64 exec, -1
    s_branch .Lo_l3
.Lo_lc3:
    v_mfma_f32_16x16x32_bf16 v[164:167], a[64:67], v[52:55], v[164:167]
    v_mfma_f32_16x16x32_bf16 v[168:171], a[68:71], v[52:55], v[168:171]
    v_mfma_f32_16x16x32_bf16 v[172:175], a[72:75], v[52:55], v[172:175]
    v_mfma_f32_16x16x32_bf16 v[176:179], a[76:79], v[52:55], v[176:179]
    v_mfma_f32_16x16x32_bf16 v[164:167], a[80:83], v[56:59], v[164:167]
    v_mfma_f32_16x16x32_bf16 v[168:171], a[84:87], v[56:59], v[168:171]
    v_mfma_f32_16x16x32_bf16 v[172:175], a[88:91], v[56:59], v[172:175]
    v_mfma_f32_16x16x32_bf16 v[176:179], a[92:95], v[56:59], v[176:179]
    v_mfma_f32_16x16x32_bf16 v[164:167], a[96:99], v[60:63], v[164:167]
    v_mfma_f32_16x16x32_bf16 v[168:171], a[100:103], v[60:63], v[168:171]
    v_mfma_f32_16x16x32_bf16 v[172:175], a[104:107], v[60:63], v[172:175]
    v_mfma_f32_16x16x32_bf16 v[176:179], a[108:111], v[60:63], v[176:179]
    v_mfma_f32_16x16x32_bf16 v[164:167], a[112:115], v[64:67], v[164:167]
    v_mfma_f32_16x16x32_bf16 v[168:171], a[116:119], v[64:67], v[168:171]
    v_mfma_f32_16x16x32_bf16 v[172:175], a[120:123], v[64:67], v[172:175]
    v_mfma_f32_16x16x32_bf16 v[176:179], a[124:127], v[64:67], v[176:179]
    s_bitset0_b32 s3, 3
.Lo_l3:
    s_cmp_lg_u32 s3, 0
    s_cbranch_scc1 .Lo_late
    s_branch .Lo_done
.section .rodata,"a"
.p2align 6
.amdhsa_kernel gated_mix__spectral_fnet__linear_kernel_hedgehog__prompt_kernel
  .amdhsa_next_free_vgpr 512
  .amdhsa_next_free_sgpr 102
  .amdhsa_accum_offset 256
  .amdhsa_group_segment_fixed_size 0
  .amdhsa_kernarg_size 104
  .amdhsa_user_sgpr_count 2
  .amdhsa_user_sgpr_kernarg_segment_ptr 1
  .amdhsa_system_sgpr_workgroup_id_x 1
.end_amdhsa_kernel
```
